```python
import torch

def _softmax(x, axis=-1):
    return torch.softmax(x, dim=axis)
def _gelu(x):
    return torch.nn.functional.gelu(x, approximate="tanh")
def _silu(x):
    return torch.nn.functional.silu(x)
def _sigmoid(x):
    return torch.sigmoid(x)
def _layernorm(x, axis=-1, eps=1e-5):
    m = x.mean(dim=axis, keepdim=True)
    v = x.var(dim=axis, keepdim=True, unbiased=False)
    return (x - m) / torch.sqrt(v + eps)
def _scatter_add(tgt, idx, src, axis=0):
    return tgt.clone().index_add_(axis, idx, src)
def _segment_sum(src, seg, n):
    out = torch.zeros((n,) + src.shape[1:], dtype=src.dtype)
    return out.index_add_(0, seg, src)
def _pad(x, pw):
    flat = tuple(v for pair in reversed(pw) for v in pair)
    return torch.nn.functional.pad(x, flat)

kernel_name = 'sequential_preLN__mha_block_cached__geglu_ffn__decode'

def setup_inputs():

    _w = (lambda a: (lambda t: t.to(torch.bfloat16) if t.is_floating_point() else t)(torch.as_tensor(a)))
    def _A_setup():
        B, Sq, D = 2, 1, 512
        H, Sk, Dh = 32, 8192, 128
        return {
            "x": _w((lambda *s: torch.randn(*s, dtype=torch.bfloat16) * 0.05)(B, Sq, D)),
            "k_cache": _w((lambda *s: torch.randn(*s, dtype=torch.bfloat16) * 3.2)(B, H, Sk, Dh)),
            "v_cache": _w((lambda *s: torch.randn(*s, dtype=torch.bfloat16) * 0.4)(B, H, Sk, Dh)),
            "wq": _w((lambda *s: torch.randn(*s, dtype=torch.bfloat16) * 3.2)(D, H * Dh) * (D ** -0.5)),
            "wo": _w((lambda *s: torch.randn(*s, dtype=torch.bfloat16) * 0.4)(H * Dh, D) * ((H * Dh) ** -0.5)),
        }
    _A_in = _A_setup()

    def _B_setup():
        B, S, D, F = 2, 1, 512, 1376
        return {
            "x": _w((lambda *s: torch.randn(*s, dtype=torch.bfloat16) * 0.05)(B, S, D)),
            "w_gate": _w((lambda *s: torch.randn(*s, dtype=torch.bfloat16) * 0.05)(D, F)),
            "w_up": _w((lambda *s: torch.randn(*s, dtype=torch.bfloat16) * 0.05)(D, F)),
            "w_down": _w((lambda *s: torch.randn(*s, dtype=torch.bfloat16) * 0.05)(F, D)),
        }
    _B_in = _B_setup()

    return {
        "A_x": _A_in["x"],
        "A_k_cache": _A_in["k_cache"],
        "A_v_cache": _A_in["v_cache"],
        "A_wq": _A_in["wq"],
        "A_wo": _A_in["wo"],
        "B_x": _B_in["x"],
        "B_w_gate": _B_in["w_gate"],
        "B_w_up": _B_in["w_up"],
        "B_w_down": _B_in["w_down"],
    }

def reference(A_x, A_k_cache, A_v_cache, A_wq, A_wo, B_x, B_w_gate, B_w_up, B_w_down):
    def _A_ref(x, k_cache, v_cache, wq, wo):
        B, Sq, D = x.shape
        H, Dh = 32, 128
        q = (lambda x, *d: x.permute(*d))((x @ wq).reshape(B, Sq, H, Dh), 0, 2, 1, 3)
        scores = torch.einsum("bhqd,bhkd->bhqk", q, k_cache) * (Dh ** -0.5)
        p = _softmax(scores, axis=-1)
        o = torch.einsum("bhqk,bhkd->bhqd", p, v_cache)
        return (lambda x, *d: x.permute(*d))(o, 0, 2, 1, 3).reshape(B, Sq, H * Dh) @ wo

    def _B_ref(x, w_gate, w_up, w_down):
        return (_gelu(x @ w_gate) * (x @ w_up)) @ w_down

    x = A_x
    h = x + _A_ref(_layernorm(x, axis=-1), A_k_cache, A_v_cache, A_wq, A_wo)
    h2 = h + _B_ref(_layernorm(h, axis=-1), B_w_gate, B_w_up, B_w_down)
    return h2
```

```asm
; @launch grid=(256,1,1) block=(512,1,1) lds=139264
.amdgcn_target "amdgcn-amd-amdhsa--gfx950"
.text
.globl sequential_preLN__mha_block_cached__geglu_ffn__decode_kernel
.p2align 8
.type sequential_preLN__mha_block_cached__geglu_ffn__decode_kernel,@function
sequential_preLN__mha_block_cached__geglu_ffn__decode_kernel:
    s_cmp_ge_u32 s2, 256
    s_cbranch_scc1 L_end
    s_load_dwordx16 s[48:63], s[0:1], 0
    s_load_dwordx8 s[64:71], s[0:1], 64
    v_lshrrev_b32 v1, 6, v0
    v_and_b32 v0, 63, v0
    v_readfirstlane_b32 s72, v1
    s_and_b32 s80, s2, 7
    s_lshr_b32 s81, s2, 3
    s_and_b32 s73, s81, 0x18
    s_add_u32 s73, s73, s80
    s_bfe_u32 s74, s81, 0x10002
    s_and_b32 s75, s81, 3
    s_cmp_ge_u32 s72, 4
    s_cbranch_scc1 L_helper
    s_lshl_b32 s82, s74, 5
    s_add_u32 s82, s82, s73
    s_lshl_b32 s76, s82, 21
    s_lshl_b32 s83, s75, 19
    s_add_u32 s76, s76, s83
    v_lshlrev_b32 v20, 4, v0
    s_lshl_b32 s83, s72, 10
    v_add_u32 v20, s83, v20
    s_lshl_b32 s76, s82, 21
    s_lshr_b32 s12, s75, 1
    s_lshl_b32 s12, s12, 20
    s_add_u32 s76, s76, s12
    s_mov_b32 s12, 1
    s_and_b32 s13, s75, 1
    s_mul_i32 s12, s12, 32768
    s_add_u32 s12, s12, 0x1000
    s_mul_i32 s13, s13, 32768
    v_add_u32 v20, s13, v20
    s_mov_b32 s6, 0x8000000
    s_mov_b32 s7, 0x20000
    s_movk_i32 s9, 0x2000
    s_movk_i32 s10, 0xf000
    s_movk_i32 s11, 0x1000
    s_waitcnt lgkmcnt(0)
    s_mov_b32 s4, s50
    s_mov_b32 s5, s51
    buffer_load_dwordx4 v[64:67], v20, s[4:7], s76 offen nt
    v_add_u32 v20, s9, v20
    buffer_load_dwordx4 v[68:71], v20, s[4:7], s76 offen nt
    v_add_u32 v20, s10, v20
    buffer_load_dwordx4 v[72:75], v20, s[4:7], s76 offen nt
    v_add_u32 v20, s9, v20
    buffer_load_dwordx4 v[76:79], v20, s[4:7], s76 offen nt
    v_add_u32 v20, s11, v20
    buffer_load_dwordx4 v[80:83], v20, s[4:7], s76 offen nt
    v_add_u32 v20, s9, v20
    buffer_load_dwordx4 v[84:87], v20, s[4:7], s76 offen nt
    v_add_u32 v20, s10, v20
    s_load_dword s14, s[52:53], s76
    s_lshl_b32 s83, s73, 17
    s_load_dword s15, s[56:57], s83
    s_load_dword s16, s[60:61], 0
    s_load_dword s17, s[62:63], 0
    s_load_dword s18, s[64:65], 0
    s_load_dword s20, s[70:71], 0x5f00
    s_barrier
    v_and_b32 v1, 1, v0
    v_lshlrev_b32 v1, 4, v1
    v_mov_b32 v7, 0xffff
    v_lshlrev_b32 v7, v1, v7
    v_bfe_u32 v1, v0, 1, 2
    v_cmp_eq_u32 vcc, 0, v1
    s_nop 1
    v_cndmask_b32 v2, 0, v7, vcc
    v_cmp_eq_u32 vcc, 1, v1
    s_nop 1
    v_cndmask_b32 v3, 0, v7, vcc
    v_cmp_eq_u32 vcc, 2, v1
    s_nop 1
    v_cndmask_b32 v4, 0, v7, vcc
    v_cmp_eq_u32 vcc, 3, v1
    s_nop 1
    v_cndmask_b32 v5, 0, v7, vcc
    s_mov_b32 s78, 0
    v_lshrrev_b32 v1, 4, v0
    v_lshlrev_b32 v6, 6, v1
    v_and_b32 v1, 7, v0
    v_lshl_add_u32 v6, v1, 3, v6
    s_mul_i32 s83, s72, 272
    v_add_u32 v6, s83, v6
    s_mov_b32 s84, 0xaaaaaaaa
    s_mov_b32 s85, 0xaaaaaaaa
    s_mov_b32 s86, 0xcccccccc
    s_mov_b32 s87, 0xcccccccc
    s_mov_b32 s94, 0x3fb8aa3b
    s_mov_b32 s95, 0x3db504f3
    v_and_b32 v1, 15, v0
    v_lshlrev_b32 v1, 7, v1
    s_lshl_b32 s83, s72, 15
    s_add_u32 s83, s83, 8192
    s_mov_b32 m0, s83
    v_lshl_add_u32 v25, v0, 4, s83
    s_waitcnt vmcnt(5)
    buffer_load_dwordx4 v[88:91], v20, s[4:7], s76 offen nt
    v_add_u32 v20, s9, v20
    s_waitcnt vmcnt(5)
    buffer_load_dwordx4 v[92:95], v20, s[4:7], s76 offen nt
    v_add_u32 v20, s12, v20
    v_and_b32 v20, 0xfffff, v20
    s_waitcnt vmcnt(5)
    buffer_load_dwordx4 v[96:99], v20, s[4:7], s76 offen nt
    v_add_u32 v20, s9, v20
    s_waitcnt vmcnt(5)
    buffer_load_dwordx4 v[100:103], v20, s[4:7], s76 offen nt
    v_add_u32 v20, s10, v20
    s_waitcnt vmcnt(5)
    buffer_load_dwordx4 v[104:107], v20, s[4:7], s76 offen nt
    v_add_u32 v20, s9, v20
    s_waitcnt vmcnt(5)
    buffer_load_dwordx4 v[108:111], v20, s[4:7], s76 offen nt
    v_add_u32 v20, s11, v20
    s_waitcnt vmcnt(5)
    buffer_load_dwordx4 v[112:115], v20, s[4:7], s76 offen nt
    v_add_u32 v20, s9, v20
    s_waitcnt vmcnt(5)
    buffer_load_dwordx4 v[116:119], v20, s[4:7], s76 offen nt
    v_add_u32 v20, s10, v20
    s_waitcnt vmcnt(5)
    buffer_load_dwordx4 v[120:123], v20, s[4:7], s76 offen nt
    v_add_u32 v20, s9, v20
    s_waitcnt vmcnt(5)
    buffer_load_dwordx4 v[124:127], v20, s[4:7], s76 offen nt
    v_add_u32 v20, s12, v20
    v_and_b32 v20, 0xfffff, v20
    s_waitcnt vmcnt(5)
    buffer_load_dwordx4 v[128:131], v20, s[4:7], s76 offen nt
    v_add_u32 v20, s9, v20
    s_waitcnt vmcnt(5)
    buffer_load_dwordx4 v[132:135], v20, s[4:7], s76 offen nt
    v_add_u32 v20, s10, v20
    s_waitcnt vmcnt(5)
    buffer_load_dwordx4 v[136:139], v20, s[4:7], s76 offen nt
    v_add_u32 v20, s9, v20
    s_waitcnt vmcnt(5)
    buffer_load_dwordx4 v[140:143], v20, s[4:7], s76 offen nt
    v_add_u32 v20, s11, v20
    s_waitcnt vmcnt(5)
    buffer_load_dwordx4 v[144:147], v20, s[4:7], s76 offen nt
    v_add_u32 v20, s9, v20
    s_waitcnt vmcnt(5)
    buffer_load_dwordx4 v[148:151], v20, s[4:7], s76 offen nt
    v_add_u32 v20, s10, v20
    s_waitcnt vmcnt(5)
    buffer_load_dwordx4 v[152:155], v20, s[4:7], s76 offen nt
    v_add_u32 v20, s9, v20
    s_waitcnt vmcnt(5)
    buffer_load_dwordx4 v[156:159], v20, s[4:7], s76 offen nt
    v_add_u32 v20, s12, v20
    v_and_b32 v20, 0xfffff, v20
    s_waitcnt vmcnt(5)
    buffer_load_dwordx4 v[160:163], v20, s[4:7], s76 offen nt
    v_add_u32 v20, s9, v20
    s_waitcnt vmcnt(5)
    buffer_load_dwordx4 v[164:167], v20, s[4:7], s76 offen nt
    v_add_u32 v20, s10, v20
    s_waitcnt vmcnt(5)
    buffer_load_dwordx4 v[168:171], v20, s[4:7], s76 offen nt
    v_add_u32 v20, s9, v20
    s_waitcnt vmcnt(5)
    buffer_load_dwordx4 v[172:175], v20, s[4:7], s76 offen nt
    v_add_u32 v20, s11, v20
    s_waitcnt vmcnt(5)
    buffer_load_dwordx4 v[176:179], v20, s[4:7], s76 offen nt
    v_add_u32 v20, s9, v20
    s_waitcnt vmcnt(5)
    buffer_load_dwordx4 v[180:183], v20, s[4:7], s76 offen nt
    v_add_u32 v20, s10, v20
    s_waitcnt vmcnt(5)
    buffer_load_dwordx4 v[184:187], v20, s[4:7], s76 offen nt
    v_add_u32 v20, s9, v20
    s_waitcnt vmcnt(5)
    buffer_load_dwordx4 v[188:191], v20, s[4:7], s76 offen nt
    v_add_u32 v20, s12, v20
    v_and_b32 v20, 0xfffff, v20
    s_waitcnt vmcnt(5)
    buffer_load_dwordx4 v[192:195], v20, s[4:7], s76 offen nt
    v_add_u32 v20, s9, v20
    s_waitcnt vmcnt(5)
    buffer_load_dwordx4 v[196:199], v20, s[4:7], s76 offen nt
    v_add_u32 v20, s10, v20
    s_waitcnt vmcnt(5)
    buffer_load_dwordx4 v[200:203], v20, s[4:7], s76 offen nt
    v_add_u32 v20, s9, v20
    s_waitcnt vmcnt(5)
    buffer_load_dwordx4 v[204:207], v20, s[4:7], s76 offen nt
    v_add_u32 v20, s11, v20
    s_waitcnt vmcnt(5)
    buffer_load_dwordx4 v[208:211], v20, s[4:7], s76 offen nt
    v_add_u32 v20, s9, v20
    s_waitcnt vmcnt(5)
    buffer_load_dwordx4 v[212:215], v20, s[4:7], s76 offen nt
    v_add_u32 v20, s10, v20
    s_waitcnt vmcnt(5)
    buffer_load_dwordx4 v[216:219], v20, s[4:7], s76 offen nt
    v_add_u32 v20, s9, v20
    s_waitcnt vmcnt(5)
    buffer_load_dwordx4 v[220:223], v20, s[4:7], s76 offen nt
    v_add_u32 v20, s12, v20
    v_and_b32 v20, 0xfffff, v20
    s_waitcnt vmcnt(5)
    buffer_load_dwordx4 v[224:227], v20, s[4:7], s76 offen nt
    v_add_u32 v20, s9, v20
    s_waitcnt vmcnt(5)
    buffer_load_dwordx4 v[228:231], v20, s[4:7], s76 offen nt
    v_add_u32 v20, s10, v20
    s_waitcnt vmcnt(5)
    buffer_load_dwordx4 v[232:235], v20, s[4:7], s76 offen nt
    v_add_u32 v20, s9, v20
    s_waitcnt vmcnt(5)
    buffer_load_dwordx4 v[236:239], v20, s[4:7], s76 offen nt
    v_add_u32 v20, s11, v20
    s_waitcnt vmcnt(5)
    buffer_load_dwordx4 v[240:243], v20, s[4:7], s76 offen nt
    v_add_u32 v20, s9, v20
    s_waitcnt vmcnt(5)
    buffer_load_dwordx4 v[244:247], v20, s[4:7], s76 offen nt
    v_add_u32 v20, s10, v20
    s_waitcnt vmcnt(5)
    buffer_load_dwordx4 v[248:251], v20, s[4:7], s76 offen nt
    v_add_u32 v20, s9, v20
    s_waitcnt vmcnt(5)
    buffer_load_dwordx4 v[252:255], v20, s[4:7], s76 offen nt
    v_add_u32 v20, s12, v20
    v_and_b32 v20, 0xfffff, v20
    s_waitcnt vmcnt(5)
    buffer_load_dwordx4 v20, s[4:7], s76 offen nt lds
    v_add_u32 v20, s9, v20
    s_add_u32 m0, m0, 0x400
    s_waitcnt vmcnt(5)
    buffer_load_dwordx4 v20, s[4:7], s76 offen nt lds
    v_add_u32 v20, s10, v20
    s_add_u32 m0, m0, 0x400
    s_waitcnt vmcnt(5)
    buffer_load_dwordx4 v20, s[4:7], s76 offen nt lds
    v_add_u32 v20, s9, v20
    s_add_u32 m0, m0, 0x400
    s_waitcnt vmcnt(5)
    buffer_load_dwordx4 v20, s[4:7], s76 offen nt lds
    v_add_u32 v20, s11, v20
    s_add_u32 m0, m0, 0x400
    s_waitcnt vmcnt(5)
    buffer_load_dwordx4 v20, s[4:7], s76 offen nt lds
    v_add_u32 v20, s9, v20
    s_add_u32 m0, m0, 0x400
    s_waitcnt vmcnt(5)
    buffer_load_dwordx4 v20, s[4:7], s76 offen nt lds
    v_add_u32 v20, s10, v20
    s_add_u32 m0, m0, 0x400
    s_waitcnt vmcnt(5)
    buffer_load_dwordx4 v20, s[4:7], s76 offen nt lds
    v_add_u32 v20, s9, v20
    s_add_u32 m0, m0, 0x400
    s_waitcnt vmcnt(5)
    buffer_load_dwordx4 v20, s[4:7], s76 offen nt lds
    v_add_u32 v20, s12, v20
    v_and_b32 v20, 0xfffff, v20
    s_add_u32 m0, m0, 0x400
    s_waitcnt vmcnt(5)
    buffer_load_dwordx4 v20, s[4:7], s76 offen nt lds
    v_add_u32 v20, s9, v20
    s_add_u32 m0, m0, 0x400
    s_waitcnt vmcnt(5)
    buffer_load_dwordx4 v20, s[4:7], s76 offen nt lds
    v_add_u32 v20, s10, v20
    s_add_u32 m0, m0, 0x400
    s_waitcnt vmcnt(5)
    buffer_load_dwordx4 v20, s[4:7], s76 offen nt lds
    v_add_u32 v20, s9, v20
    s_add_u32 m0, m0, 0x400
    s_waitcnt vmcnt(5)
    buffer_load_dwordx4 v20, s[4:7], s76 offen nt lds
    v_add_u32 v20, s11, v20
    s_add_u32 m0, m0, 0x400
    s_waitcnt vmcnt(5)
    buffer_load_dwordx4 v20, s[4:7], s76 offen nt lds
    v_add_u32 v20, s9, v20
    s_add_u32 m0, m0, 0x400
    s_waitcnt vmcnt(5)
    buffer_load_dwordx4 v20, s[4:7], s76 offen nt lds
    v_add_u32 v20, s10, v20
    s_add_u32 m0, m0, 0x400
    s_waitcnt vmcnt(5)
    buffer_load_dwordx4 v20, s[4:7], s76 offen nt lds
    v_add_u32 v20, s9, v20
    s_add_u32 m0, m0, 0x400
    s_waitcnt vmcnt(5)
    buffer_load_dwordx4 v20, s[4:7], s76 offen nt lds
    v_add_u32 v20, s12, v20
    v_and_b32 v20, 0xfffff, v20
    s_add_u32 m0, m0, 0x400
    s_waitcnt vmcnt(5)
    buffer_load_dwordx4 v20, s[4:7], s76 offen nt lds
    v_add_u32 v20, s9, v20
    s_add_u32 m0, m0, 0x400
    s_waitcnt vmcnt(5)
    buffer_load_dwordx4 v20, s[4:7], s76 offen nt lds
    v_add_u32 v20, s10, v20
    s_add_u32 m0, m0, 0x400
    s_waitcnt vmcnt(5)
    buffer_load_dwordx4 v20, s[4:7], s76 offen nt lds
    v_add_u32 v20, s9, v20
    s_add_u32 m0, m0, 0x400
    s_waitcnt vmcnt(5)
    buffer_load_dwordx4 v20, s[4:7], s76 offen nt lds
    v_add_u32 v20, s11, v20
    s_add_u32 m0, m0, 0x400
    s_waitcnt vmcnt(5)
    buffer_load_dwordx4 v20, s[4:7], s76 offen nt lds
    v_add_u32 v20, s9, v20
    s_add_u32 m0, m0, 0x400
    s_waitcnt vmcnt(5)
    buffer_load_dwordx4 v20, s[4:7], s76 offen nt lds
    v_add_u32 v20, s10, v20
    s_add_u32 m0, m0, 0x400
    s_waitcnt vmcnt(5)
    buffer_load_dwordx4 v20, s[4:7], s76 offen nt lds
    v_add_u32 v20, s9, v20
    s_add_u32 m0, m0, 0x400
    s_waitcnt vmcnt(5)
    buffer_load_dwordx4 v20, s[4:7], s76 offen nt lds
    v_add_u32 v20, s12, v20
    v_and_b32 v20, 0xfffff, v20
    s_add_u32 m0, m0, 0x400
    s_waitcnt vmcnt(5)
    buffer_load_dwordx4 v20, s[4:7], s76 offen nt lds
    v_add_u32 v20, s9, v20
    s_add_u32 m0, m0, 0x400
    s_waitcnt vmcnt(5)
    buffer_load_dwordx4 v20, s[4:7], s76 offen nt lds
    v_add_u32 v20, s10, v20
    s_add_u32 m0, m0, 0x400
    s_waitcnt vmcnt(5)
    buffer_load_dwordx4 v20, s[4:7], s76 offen nt lds
    v_add_u32 v20, s9, v20
    s_add_u32 m0, m0, 0x400
    s_waitcnt vmcnt(5)
    buffer_load_dwordx4 v20, s[4:7], s76 offen nt lds
    v_add_u32 v20, s11, v20
    s_add_u32 m0, m0, 0x400
    s_waitcnt vmcnt(5)
    buffer_load_dwordx4 v20, s[4:7], s76 offen nt lds
    v_add_u32 v20, s9, v20
    s_add_u32 m0, m0, 0x400
    s_mov_b32 s92, 0
    v_mov_b32 v26, 0
L_q_spin:
    ds_read_b128 v[32:35], v26 offset:7216
    s_waitcnt lgkmcnt(0)
    v_max3_u32 v32, v32, v33, v34
    v_max_u32 v32, v32, v35
    v_cmp_eq_u32 vcc, -1, v32
    s_cbranch_vccz L_q_ok
    s_sleep 2
    s_add_u32 s92, s92, 1
    s_cmp_lt_u32 s92, 65536
    s_cbranch_scc1 L_q_spin
    s_mov_b64 exec, -1
L_q_ok:
    s_nop 1
    ds_read_b128 v[32:35], v1 offset:0
    ds_read_b128 v[36:39], v1 offset:16
    ds_read_b128 v[40:43], v1 offset:32
    ds_read_b128 v[44:47], v1 offset:48
    ds_read_b128 v[48:51], v1 offset:64
    ds_read_b128 v[52:55], v1 offset:80
    ds_read_b128 v[56:59], v1 offset:96
    ds_read_b128 v[60:63], v1 offset:112
    s_waitcnt vmcnt(5)
    buffer_load_dwordx4 v20, s[4:7], s76 offen nt lds
    v_add_u32 v20, s10, v20
    s_add_u32 m0, m0, 0x400
    s_waitcnt lgkmcnt(7)
    v_pk_add_f32 v[32:33], v[32:33], v[34:35]
    v_add_f32 v32, v32, v33
    s_waitcnt lgkmcnt(6)
    v_pk_add_f32 v[36:37], v[36:37], v[38:39]
    v_add_f32 v36, v36, v37
    s_waitcnt lgkmcnt(5)
    v_pk_add_f32 v[40:41], v[40:41], v[42:43]
    v_add_f32 v40, v40, v41
    s_waitcnt lgkmcnt(4)
    v_pk_add_f32 v[44:45], v[44:45], v[46:47]
    v_add_f32 v44, v44, v45
    s_waitcnt lgkmcnt(3)
    v_pk_add_f32 v[48:49], v[48:49], v[50:51]
    v_add_f32 v48, v48, v49
    s_waitcnt lgkmcnt(2)
    v_pk_add_f32 v[52:53], v[52:53], v[54:55]
    v_add_f32 v52, v52, v53
    s_waitcnt lgkmcnt(1)
    v_pk_add_f32 v[56:57], v[56:57], v[58:59]
    v_add_f32 v56, v56, v57
    s_waitcnt lgkmcnt(0)
    v_pk_add_f32 v[60:61], v[60:61], v[62:63]
    v_add_f32 v60, v60, v61
    v_cvt_pk_bf16_f32 v21, v32, v36
    v_cvt_pk_bf16_f32 v22, v40, v44
    v_cvt_pk_bf16_f32 v23, v48, v52
    v_cvt_pk_bf16_f32 v24, v56, v60
    s_waitcnt vmcnt(5)
    buffer_load_dwordx4 v20, s[4:7], s76 offen nt lds
    v_add_u32 v20, s9, v20
    s_add_u32 m0, m0, 0x400
    s_waitcnt vmcnt(5)
    buffer_load_dwordx4 v20, s[4:7], s76 offen nt lds
    v_add_u32 v20, s12, v20
    v_and_b32 v20, 0xfffff, v20
    s_add_u32 m0, m0, 0x400
    s_mov_b32 s8, 0
    s_cmp_lg_u32 s78, 0
    v_dot2_f32_bf16 v32, v192, v21, 0
    v_dot2_f32_bf16 v32, v193, v22, v32
    v_dot2_f32_bf16 v32, v194, v23, v32
    v_dot2_f32_bf16 v32, v195, v24, v32
    v_dot2_f32_bf16 v33, v196, v21, 0
    v_dot2_f32_bf16 v33, v197, v22, v33
    v_dot2_f32_bf16 v33, v198, v23, v33
    v_dot2_f32_bf16 v33, v199, v24, v33
    v_dot2_f32_bf16 v34, v200, v21, 0
    v_dot2_f32_bf16 v34, v201, v22, v34
    v_dot2_f32_bf16 v34, v202, v23, v34
    v_dot2_f32_bf16 v34, v203, v24, v34
    s_waitcnt vmcnt(4)
    buffer_load_dwordx4 v[192:195], v20, s[4:7], s76 offen nt
    v_add_u32 v20, s9, v20
    v_dot2_f32_bf16 v35, v204, v21, 0
    v_dot2_f32_bf16 v35, v205, v22, v35
    v_dot2_f32_bf16 v35, v206, v23, v35
    v_dot2_f32_bf16 v35, v207, v24, v35
    v_dot2_f32_bf16 v36, v208, v21, 0
    v_dot2_f32_bf16 v36, v209, v22, v36
    v_dot2_f32_bf16 v36, v210, v23, v36
    v_dot2_f32_bf16 v36, v211, v24, v36
    v_dot2_f32_bf16 v37, v212, v21, 0
    v_dot2_f32_bf16 v37, v213, v22, v37
    v_dot2_f32_bf16 v37, v214, v23, v37
    v_dot2_f32_bf16 v37, v215, v24, v37
    s_waitcnt vmcnt(4)
    buffer_load_dwordx4 v[196:199], v20, s[4:7], s76 offen nt
    v_add_u32 v20, s10, v20
    v_dot2_f32_bf16 v38, v216, v21, 0
    v_dot2_f32_bf16 v38, v217, v22, v38
    v_dot2_f32_bf16 v38, v218, v23, v38
    v_dot2_f32_bf16 v38, v219, v24, v38
    v_dot2_f32_bf16 v39, v220, v21, 0
    v_dot2_f32_bf16 v39, v221, v22, v39
    v_dot2_f32_bf16 v39, v222, v23, v39
    v_dot2_f32_bf16 v39, v223, v24, v39
    v_dot2_f32_bf16 v40, v224, v21, 0
    v_dot2_f32_bf16 v40, v225, v22, v40
    v_dot2_f32_bf16 v40, v226, v23, v40
    v_dot2_f32_bf16 v40, v227, v24, v40
    s_waitcnt vmcnt(4)
    buffer_load_dwordx4 v[200:203], v20, s[4:7], s76 offen nt
    v_add_u32 v20, s9, v20
    v_dot2_f32_bf16 v41, v228, v21, 0
    v_dot2_f32_bf16 v41, v229, v22, v41
    v_dot2_f32_bf16 v41, v230, v23, v41
    v_dot2_f32_bf16 v41, v231, v24, v41
    v_dot2_f32_bf16 v42, v232, v21, 0
    v_dot2_f32_bf16 v42, v233, v22, v42
    v_dot2_f32_bf16 v42, v234, v23, v42
    v_dot2_f32_bf16 v42, v235, v24, v42
    v_dot2_f32_bf16 v43, v236, v21, 0
    v_dot2_f32_bf16 v43, v237, v22, v43
    v_dot2_f32_bf16 v43, v238, v23, v43
    v_dot2_f32_bf16 v43, v239, v24, v43
    s_waitcnt vmcnt(4)
    buffer_load_dwordx4 v[204:207], v20, s[4:7], s76 offen nt
    v_add_u32 v20, s11, v20
    v_dot2_f32_bf16 v44, v240, v21, 0
    v_dot2_f32_bf16 v44, v241, v22, v44
    v_dot2_f32_bf16 v44, v242, v23, v44
    v_dot2_f32_bf16 v44, v243, v24, v44
    v_dot2_f32_bf16 v45, v244, v21, 0
    v_dot2_f32_bf16 v45, v245, v22, v45
    v_dot2_f32_bf16 v45, v246, v23, v45
    v_dot2_f32_bf16 v45, v247, v24, v45
    v_dot2_f32_bf16 v46, v248, v21, 0
    v_dot2_f32_bf16 v46, v249, v22, v46
    v_dot2_f32_bf16 v46, v250, v23, v46
    v_dot2_f32_bf16 v46, v251, v24, v46
    s_waitcnt vmcnt(4)
    buffer_load_dwordx4 v[208:211], v20, s[4:7], s76 offen nt
    v_add_u32 v20, s9, v20
    v_dot2_f32_bf16 v47, v252, v21, 0
    v_dot2_f32_bf16 v47, v253, v22, v47
    v_dot2_f32_bf16 v47, v254, v23, v47
    v_dot2_f32_bf16 v47, v255, v24, v47
    v_add_f32_dpp v32, v32, v32 row_ror:8 row_mask:0xf bank_mask:0x3
    v_add_f32_dpp v33, v33, v33 row_ror:8 row_mask:0xf bank_mask:0x3
    v_add_f32_dpp v34, v34, v34 row_ror:8 row_mask:0xf bank_mask:0x3
    v_add_f32_dpp v35, v35, v35 row_ror:8 row_mask:0xf bank_mask:0x3
    v_add_f32_dpp v36, v36, v36 row_ror:8 row_mask:0xf bank_mask:0x3
    v_add_f32_dpp v37, v37, v37 row_ror:8 row_mask:0xf bank_mask:0x3
    v_add_f32_dpp v38, v38, v38 row_ror:8 row_mask:0xf bank_mask:0x3
    v_add_f32_dpp v39, v39, v39 row_ror:8 row_mask:0xf bank_mask:0x3
    v_add_f32_dpp v32, v40, v40 row_ror:8 row_mask:0xf bank_mask:0xc
    v_add_f32_dpp v33, v41, v41 row_ror:8 row_mask:0xf bank_mask:0xc
    v_add_f32_dpp v34, v42, v42 row_ror:8 row_mask:0xf bank_mask:0xc
    v_add_f32_dpp v35, v43, v43 row_ror:8 row_mask:0xf bank_mask:0xc
    v_add_f32_dpp v36, v44, v44 row_ror:8 row_mask:0xf bank_mask:0xc
    v_add_f32_dpp v37, v45, v45 row_ror:8 row_mask:0xf bank_mask:0xc
    v_add_f32_dpp v38, v46, v46 row_ror:8 row_mask:0xf bank_mask:0xc
    v_add_f32_dpp v39, v47, v47 row_ror:8 row_mask:0xf bank_mask:0xc
    v_add_f32_dpp v32, v32, v32 row_half_mirror row_mask:0xf bank_mask:0x5
    v_add_f32_dpp v33, v33, v33 row_half_mirror row_mask:0xf bank_mask:0x5
    v_add_f32_dpp v34, v34, v34 row_half_mirror row_mask:0xf bank_mask:0x5
    v_add_f32_dpp v35, v35, v35 row_half_mirror row_mask:0xf bank_mask:0x5
    v_add_f32_dpp v32, v36, v36 row_half_mirror row_mask:0xf bank_mask:0xa
    v_add_f32_dpp v33, v37, v37 row_half_mirror row_mask:0xf bank_mask:0xa
    v_add_f32_dpp v34, v38, v38 row_half_mirror row_mask:0xf bank_mask:0xa
    v_add_f32_dpp v35, v39, v39 row_half_mirror row_mask:0xf bank_mask:0xa
    v_add_f32_dpp v32, v32, v32 quad_perm:[1,0,3,2] row_mask:0xf bank_mask:0xf
    v_add_f32_dpp v33, v33, v33 quad_perm:[1,0,3,2] row_mask:0xf bank_mask:0xf
    v_add_f32_dpp v34, v34, v34 quad_perm:[1,0,3,2] row_mask:0xf bank_mask:0xf
    v_add_f32_dpp v35, v35, v35 quad_perm:[1,0,3,2] row_mask:0xf bank_mask:0xf
    v_cndmask_b32 v32, v32, v33, s[84:85]
    v_cndmask_b32 v34, v34, v35, s[84:85]
    s_nop 0
    v_add_f32_dpp v32, v32, v32 quad_perm:[2,3,0,1] row_mask:0xf bank_mask:0xf
    v_add_f32_dpp v34, v34, v34 quad_perm:[2,3,0,1] row_mask:0xf bank_mask:0xf
    v_cndmask_b32 v55, v32, v34, s[86:87]
    v_cvt_pk_bf16_f32 v55, v55, v55
    v_and_b32 v55, 0xffff0000, v55
    v_mul_f32 v55, s95, v55
    v_cvt_pk_bf16_f32 v55, v55, v55
    v_and_b32 v55, 0xffff0000, v55
    v_dot2_f32_bf16 v32, v64, v21, 0
    v_dot2_f32_bf16 v32, v65, v22, v32
    v_dot2_f32_bf16 v32, v66, v23, v32
    v_dot2_f32_bf16 v32, v67, v24, v32
    ds_read_b128 v[64:67], v25 offset:0
    v_dot2_f32_bf16 v33, v68, v21, 0
    v_dot2_f32_bf16 v33, v69, v22, v33
    v_dot2_f32_bf16 v33, v70, v23, v33
    v_dot2_f32_bf16 v33, v71, v24, v33
    ds_read_b128 v[68:71], v25 offset:1024
    s_waitcnt vmcnt(4)
    buffer_load_dwordx4 v[212:215], v20, s[4:7], s76 offen nt
    v_add_u32 v20, s10, v20
    v_dot2_f32_bf16 v34, v72, v21, 0
    v_dot2_f32_bf16 v34, v73, v22, v34
    v_dot2_f32_bf16 v34, v74, v23, v34
    v_dot2_f32_bf16 v34, v75, v24, v34
    ds_read_b128 v[72:75], v25 offset:2048
    v_dot2_f32_bf16 v35, v76, v21, 0
    v_dot2_f32_bf16 v35, v77, v22, v35
    v_dot2_f32_bf16 v35, v78, v23, v35
    v_dot2_f32_bf16 v35, v79, v24, v35
    ds_read_b128 v[76:79], v25 offset:3072
    v_dot2_f32_bf16 v36, v80, v21, 0
    v_dot2_f32_bf16 v36, v81, v22, v36
    v_dot2_f32_bf16 v36, v82, v23, v36
    v_dot2_f32_bf16 v36, v83, v24, v36
    ds_read_b128 v[80:83], v25 offset:4096
    s_waitcnt vmcnt(4)
    buffer_load_dwordx4 v[216:219], v20, s[4:7], s76 offen nt
    v_add_u32 v20, s9, v20
    v_dot2_f32_bf16 v37, v84, v21, 0
    v_dot2_f32_bf16 v37, v85, v22, v37
    v_dot2_f32_bf16 v37, v86, v23, v37
    v_dot2_f32_bf16 v37, v87, v24, v37
    ds_read_b128 v[84:87], v25 offset:5120
    v_dot2_f32_bf16 v38, v88, v21, 0
    v_dot2_f32_bf16 v38, v89, v22, v38
    v_dot2_f32_bf16 v38, v90, v23, v38
    v_dot2_f32_bf16 v38, v91, v24, v38
    ds_read_b128 v[88:91], v25 offset:6144
    v_dot2_f32_bf16 v39, v92, v21, 0
    v_dot2_f32_bf16 v39, v93, v22, v39
    v_dot2_f32_bf16 v39, v94, v23, v39
    v_dot2_f32_bf16 v39, v95, v24, v39
    ds_read_b128 v[92:95], v25 offset:7168
    s_waitcnt vmcnt(4)
    buffer_load_dwordx4 v[220:223], v20, s[4:7], s76 offen nt
    v_add_u32 v20, s12, v20
    v_and_b32 v20, 0xfffff, v20
    v_dot2_f32_bf16 v40, v96, v21, 0
    v_dot2_f32_bf16 v40, v97, v22, v40
    v_dot2_f32_bf16 v40, v98, v23, v40
    v_dot2_f32_bf16 v40, v99, v24, v40
    ds_read_b128 v[96:99], v25 offset:8192
    v_dot2_f32_bf16 v41, v100, v21, 0
    v_dot2_f32_bf16 v41, v101, v22, v41
    v_dot2_f32_bf16 v41, v102, v23, v41
    v_dot2_f32_bf16 v41, v103, v24, v41
    ds_read_b128 v[100:103], v25 offset:9216
    v_dot2_f32_bf16 v42, v104, v21, 0
    v_dot2_f32_bf16 v42, v105, v22, v42
    v_dot2_f32_bf16 v42, v106, v23, v42
    v_dot2_f32_bf16 v42, v107, v24, v42
    ds_read_b128 v[104:107], v25 offset:10240
    s_waitcnt vmcnt(4)
    buffer_load_dwordx4 v[224:227], v20, s[4:7], s76 offen nt
    v_add_u32 v20, s9, v20
    v_dot2_f32_bf16 v43, v108, v21, 0
    v_dot2_f32_bf16 v43, v109, v22, v43
    v_dot2_f32_bf16 v43, v110, v23, v43
    v_dot2_f32_bf16 v43, v111, v24, v43
    ds_read_b128 v[108:111], v25 offset:11264
    v_dot2_f32_bf16 v44, v112, v21, 0
    v_dot2_f32_bf16 v44, v113, v22, v44
    v_dot2_f32_bf16 v44, v114, v23, v44
    v_dot2_f32_bf16 v44, v115, v24, v44
    ds_read_b128 v[112:115], v25 offset:12288
    v_dot2_f32_bf16 v45, v116, v21, 0
    v_dot2_f32_bf16 v45, v117, v22, v45
    v_dot2_f32_bf16 v45, v118, v23, v45
    v_dot2_f32_bf16 v45, v119, v24, v45
    ds_read_b128 v[116:119], v25 offset:13312
    s_waitcnt vmcnt(4)
    buffer_load_dwordx4 v[228:231], v20, s[4:7], s76 offen nt
    v_add_u32 v20, s10, v20
    v_dot2_f32_bf16 v46, v120, v21, 0
    v_dot2_f32_bf16 v46, v121, v22, v46
    v_dot2_f32_bf16 v46, v122, v23, v46
    v_dot2_f32_bf16 v46, v123, v24, v46
    ds_read_b128 v[120:123], v25 offset:14336
    v_dot2_f32_bf16 v47, v124, v21, 0
    v_dot2_f32_bf16 v47, v125, v22, v47
    v_dot2_f32_bf16 v47, v126, v23, v47
    v_dot2_f32_bf16 v47, v127, v24, v47
    ds_read_b128 v[124:127], v25 offset:15360
    v_add_f32_dpp v32, v32, v32 row_ror:8 row_mask:0xf bank_mask:0x3
    v_add_f32_dpp v33, v33, v33 row_ror:8 row_mask:0xf bank_mask:0x3
    v_add_f32_dpp v34, v34, v34 row_ror:8 row_mask:0xf bank_mask:0x3
    v_add_f32_dpp v35, v35, v35 row_ror:8 row_mask:0xf bank_mask:0x3
    v_add_f32_dpp v36, v36, v36 row_ror:8 row_mask:0xf bank_mask:0x3
    v_add_f32_dpp v37, v37, v37 row_ror:8 row_mask:0xf bank_mask:0x3
    v_add_f32_dpp v38, v38, v38 row_ror:8 row_mask:0xf bank_mask:0x3
    v_add_f32_dpp v39, v39, v39 row_ror:8 row_mask:0xf bank_mask:0x3
    v_add_f32_dpp v32, v40, v40 row_ror:8 row_mask:0xf bank_mask:0xc
    v_add_f32_dpp v33, v41, v41 row_ror:8 row_mask:0xf bank_mask:0xc
    v_add_f32_dpp v34, v42, v42 row_ror:8 row_mask:0xf bank_mask:0xc
    v_add_f32_dpp v35, v43, v43 row_ror:8 row_mask:0xf bank_mask:0xc
    v_add_f32_dpp v36, v44, v44 row_ror:8 row_mask:0xf bank_mask:0xc
    v_add_f32_dpp v37, v45, v45 row_ror:8 row_mask:0xf bank_mask:0xc
    v_add_f32_dpp v38, v46, v46 row_ror:8 row_mask:0xf bank_mask:0xc
    v_add_f32_dpp v39, v47, v47 row_ror:8 row_mask:0xf bank_mask:0xc
    v_add_f32_dpp v32, v32, v32 row_half_mirror row_mask:0xf bank_mask:0x5
    v_add_f32_dpp v33, v33, v33 row_half_mirror row_mask:0xf bank_mask:0x5
    v_add_f32_dpp v34, v34, v34 row_half_mirror row_mask:0xf bank_mask:0x5
    v_add_f32_dpp v35, v35, v35 row_half_mirror row_mask:0xf bank_mask:0x5
    v_add_f32_dpp v32, v36, v36 row_half_mirror row_mask:0xf bank_mask:0xa
    v_add_f32_dpp v33, v37, v37 row_half_mirror row_mask:0xf bank_mask:0xa
    v_add_f32_dpp v34, v38, v38 row_half_mirror row_mask:0xf bank_mask:0xa
    v_add_f32_dpp v35, v39, v39 row_half_mirror row_mask:0xf bank_mask:0xa
    v_add_f32_dpp v32, v32, v32 quad_perm:[1,0,3,2] row_mask:0xf bank_mask:0xf
    v_add_f32_dpp v33, v33, v33 quad_perm:[1,0,3,2] row_mask:0xf bank_mask:0xf
    v_add_f32_dpp v34, v34, v34 quad_perm:[1,0,3,2] row_mask:0xf bank_mask:0xf
    v_add_f32_dpp v35, v35, v35 quad_perm:[1,0,3,2] row_mask:0xf bank_mask:0xf
    v_cndmask_b32 v32, v32, v33, s[84:85]
    v_cndmask_b32 v34, v34, v35, s[84:85]
    s_nop 0
    v_add_f32_dpp v32, v32, v32 quad_perm:[2,3,0,1] row_mask:0xf bank_mask:0xf
    v_add_f32_dpp v34, v34, v34 quad_perm:[2,3,0,1] row_mask:0xf bank_mask:0xf
    v_cndmask_b32 v53, v32, v34, s[86:87]
    v_cvt_pk_bf16_f32 v53, v53, v53
    v_and_b32 v53, 0xffff0000, v53
    v_mul_f32 v53, s95, v53
    v_cvt_pk_bf16_f32 v53, v53, v53
    v_and_b32 v53, 0xffff0000, v53
    v_dot2_f32_bf16 v32, v128, v21, 0
    v_dot2_f32_bf16 v32, v129, v22, v32
    v_dot2_f32_bf16 v32, v130, v23, v32
    v_dot2_f32_bf16 v32, v131, v24, v32
    ds_read_b128 v[128:131], v25 offset:16384
    s_waitcnt vmcnt(4)
    buffer_load_dwordx4 v[232:235], v20, s[4:7], s76 offen nt
    v_add_u32 v20, s9, v20
    v_dot2_f32_bf16 v33, v132, v21, 0
    v_dot2_f32_bf16 v33, v133, v22, v33
    v_dot2_f32_bf16 v33, v134, v23, v33
    v_dot2_f32_bf16 v33, v135, v24, v33
    ds_read_b128 v[132:135], v25 offset:17408
    v_dot2_f32_bf16 v34, v136, v21, 0
    v_dot2_f32_bf16 v34, v137, v22, v34
    v_dot2_f32_bf16 v34, v138, v23, v34
    v_dot2_f32_bf16 v34, v139, v24, v34
    ds_read_b128 v[136:139], v25 offset:18432
    v_dot2_f32_bf16 v35, v140, v21, 0
    v_dot2_f32_bf16 v35, v141, v22, v35
    v_dot2_f32_bf16 v35, v142, v23, v35
    v_dot2_f32_bf16 v35, v143, v24, v35
    ds_read_b128 v[140:143], v25 offset:19456
    s_waitcnt vmcnt(4)
    buffer_load_dwordx4 v[236:239], v20, s[4:7], s76 offen nt
    v_add_u32 v20, s11, v20
    v_dot2_f32_bf16 v36, v144, v21, 0
    v_dot2_f32_bf16 v36, v145, v22, v36
    v_dot2_f32_bf16 v36, v146, v23, v36
    v_dot2_f32_bf16 v36, v147, v24, v36
    ds_read_b128 v[144:147], v25 offset:20480
    v_dot2_f32_bf16 v37, v148, v21, 0
    v_dot2_f32_bf16 v37, v149, v22, v37
    v_dot2_f32_bf16 v37, v150, v23, v37
    v_dot2_f32_bf16 v37, v151, v24, v37
    ds_read_b128 v[148:151], v25 offset:21504
    v_dot2_f32_bf16 v38, v152, v21, 0
    v_dot2_f32_bf16 v38, v153, v22, v38
    v_dot2_f32_bf16 v38, v154, v23, v38
    v_dot2_f32_bf16 v38, v155, v24, v38
    ds_read_b128 v[152:155], v25 offset:22528
    s_waitcnt vmcnt(4)
    buffer_load_dwordx4 v[240:243], v20, s[4:7], s76 offen nt
    v_add_u32 v20, s9, v20
    v_dot2_f32_bf16 v39, v156, v21, 0
    v_dot2_f32_bf16 v39, v157, v22, v39
    v_dot2_f32_bf16 v39, v158, v23, v39
    v_dot2_f32_bf16 v39, v159, v24, v39
    ds_read_b128 v[156:159], v25 offset:23552
    v_dot2_f32_bf16 v40, v160, v21, 0
    v_dot2_f32_bf16 v40, v161, v22, v40
    v_dot2_f32_bf16 v40, v162, v23, v40
    v_dot2_f32_bf16 v40, v163, v24, v40
    ds_read_b128 v[160:163], v25 offset:24576
    v_dot2_f32_bf16 v41, v164, v21, 0
    v_dot2_f32_bf16 v41, v165, v22, v41
    v_dot2_f32_bf16 v41, v166, v23, v41
    v_dot2_f32_bf16 v41, v167, v24, v41
    ds_read_b128 v[164:167], v25 offset:25600
    s_waitcnt vmcnt(4)
    buffer_load_dwordx4 v[244:247], v20, s[4:7], s76 offen nt
    v_add_u32 v20, s10, v20
    v_dot2_f32_bf16 v42, v168, v21, 0
    v_dot2_f32_bf16 v42, v169, v22, v42
    v_dot2_f32_bf16 v42, v170, v23, v42
    v_dot2_f32_bf16 v42, v171, v24, v42
    ds_read_b128 v[168:171], v25 offset:26624
    v_dot2_f32_bf16 v43, v172, v21, 0
    v_dot2_f32_bf16 v43, v173, v22, v43
    v_dot2_f32_bf16 v43, v174, v23, v43
    v_dot2_f32_bf16 v43, v175, v24, v43
    ds_read_b128 v[172:175], v25 offset:27648
    v_dot2_f32_bf16 v44, v176, v21, 0
    v_dot2_f32_bf16 v44, v177, v22, v44
    v_dot2_f32_bf16 v44, v178, v23, v44
    v_dot2_f32_bf16 v44, v179, v24, v44
    ds_read_b128 v[176:179], v25 offset:28672
    s_waitcnt vmcnt(4)
    buffer_load_dwordx4 v[248:251], v20, s[4:7], s76 offen nt
    v_add_u32 v20, s9, v20
    v_dot2_f32_bf16 v45, v180, v21, 0
    v_dot2_f32_bf16 v45, v181, v22, v45
    v_dot2_f32_bf16 v45, v182, v23, v45
    v_dot2_f32_bf16 v45, v183, v24, v45
    ds_read_b128 v[180:183], v25 offset:29696
    v_dot2_f32_bf16 v46, v184, v21, 0
    v_dot2_f32_bf16 v46, v185, v22, v46
    v_dot2_f32_bf16 v46, v186, v23, v46
    v_dot2_f32_bf16 v46, v187, v24, v46
    ds_read_b128 v[184:187], v25 offset:30720
    v_dot2_f32_bf16 v47, v188, v21, 0
    v_dot2_f32_bf16 v47, v189, v22, v47
    v_dot2_f32_bf16 v47, v190, v23, v47
    v_dot2_f32_bf16 v47, v191, v24, v47
    ds_read_b128 v[188:191], v25 offset:31744
    s_waitcnt vmcnt(4)
    buffer_load_dwordx4 v[252:255], v20, s[4:7], s76 offen nt
    v_add_u32 v20, s12, v20
    v_and_b32 v20, 0xfffff, v20
    v_add_f32_dpp v32, v32, v32 row_ror:8 row_mask:0xf bank_mask:0x3
    v_add_f32_dpp v33, v33, v33 row_ror:8 row_mask:0xf bank_mask:0x3
    v_add_f32_dpp v34, v34, v34 row_ror:8 row_mask:0xf bank_mask:0x3
    v_add_f32_dpp v35, v35, v35 row_ror:8 row_mask:0xf bank_mask:0x3
    v_add_f32_dpp v36, v36, v36 row_ror:8 row_mask:0xf bank_mask:0x3
    v_add_f32_dpp v37, v37, v37 row_ror:8 row_mask:0xf bank_mask:0x3
    v_add_f32_dpp v38, v38, v38 row_ror:8 row_mask:0xf bank_mask:0x3
    v_add_f32_dpp v39, v39, v39 row_ror:8 row_mask:0xf bank_mask:0x3
    v_add_f32_dpp v32, v40, v40 row_ror:8 row_mask:0xf bank_mask:0xc
    v_add_f32_dpp v33, v41, v41 row_ror:8 row_mask:0xf bank_mask:0xc
    v_add_f32_dpp v34, v42, v42 row_ror:8 row_mask:0xf bank_mask:0xc
    v_add_f32_dpp v35, v43, v43 row_ror:8 row_mask:0xf bank_mask:0xc
    v_add_f32_dpp v36, v44, v44 row_ror:8 row_mask:0xf bank_mask:0xc
    v_add_f32_dpp v37, v45, v45 row_ror:8 row_mask:0xf bank_mask:0xc
    v_add_f32_dpp v38, v46, v46 row_ror:8 row_mask:0xf bank_mask:0xc
    v_add_f32_dpp v39, v47, v47 row_ror:8 row_mask:0xf bank_mask:0xc
    v_add_f32_dpp v32, v32, v32 row_half_mirror row_mask:0xf bank_mask:0x5
    v_add_f32_dpp v33, v33, v33 row_half_mirror row_mask:0xf bank_mask:0x5
    v_add_f32_dpp v34, v34, v34 row_half_mirror row_mask:0xf bank_mask:0x5
    v_add_f32_dpp v35, v35, v35 row_half_mirror row_mask:0xf bank_mask:0x5
    v_add_f32_dpp v32, v36, v36 row_half_mirror row_mask:0xf bank_mask:0xa
    v_add_f32_dpp v33, v37, v37 row_half_mirror row_mask:0xf bank_mask:0xa
    v_add_f32_dpp v34, v38, v38 row_half_mirror row_mask:0xf bank_mask:0xa
    v_add_f32_dpp v35, v39, v39 row_half_mirror row_mask:0xf bank_mask:0xa
    v_add_f32_dpp v32, v32, v32 quad_perm:[1,0,3,2] row_mask:0xf bank_mask:0xf
    v_add_f32_dpp v33, v33, v33 quad_perm:[1,0,3,2] row_mask:0xf bank_mask:0xf
    v_add_f32_dpp v34, v34, v34 quad_perm:[1,0,3,2] row_mask:0xf bank_mask:0xf
    v_add_f32_dpp v35, v35, v35 quad_perm:[1,0,3,2] row_mask:0xf bank_mask:0xf
    v_cndmask_b32 v32, v32, v33, s[84:85]
    v_cndmask_b32 v34, v34, v35, s[84:85]
    s_nop 0
    v_add_f32_dpp v32, v32, v32 quad_perm:[2,3,0,1] row_mask:0xf bank_mask:0xf
    v_add_f32_dpp v34, v34, v34 quad_perm:[2,3,0,1] row_mask:0xf bank_mask:0xf
    v_cndmask_b32 v54, v32, v34, s[86:87]
    v_cvt_pk_bf16_f32 v54, v54, v54
    v_and_b32 v54, 0xffff0000, v54
    v_mul_f32 v54, s95, v54
    v_cvt_pk_bf16_f32 v54, v54, v54
    v_and_b32 v54, 0xffff0000, v54
    s_waitcnt lgkmcnt(0)
    s_mov_b32 s8, 1
.p2align 6
L_kloop:
    v_mov_b32 v48, v49
    v_mov_b32 v49, v50
    v_mov_b32 v50, v51
    v_mov_b32 v51, v52
    v_mov_b32 v52, v53
    v_mov_b32 v53, v54
    v_mov_b32 v54, v55
    s_cmp_lg_u32 s78, 0
    v_dot2_f32_bf16 v32, v64, v21, 0
    v_dot2_f32_bf16 v32, v65, v22, v32
    v_dot2_f32_bf16 v32, v66, v23, v32
    v_dot2_f32_bf16 v32, v67, v24, v32
    s_waitcnt vmcnt(4)
    buffer_load_dwordx4 v[64:67], v20, s[4:7], s76 offen nt
    v_add_u32 v20, s9, v20
    v_dot2_f32_bf16 v33, v68, v21, 0
    v_dot2_f32_bf16 v33, v69, v22, v33
    v_dot2_f32_bf16 v33, v70, v23, v33
    v_dot2_f32_bf16 v33, v71, v24, v33
    s_waitcnt vmcnt(4)
    buffer_load_dwordx4 v[68:71], v20, s[4:7], s76 offen nt
    v_add_u32 v20, s10, v20
    v_dot2_f32_bf16 v34, v72, v21, 0
    v_dot2_f32_bf16 v34, v73, v22, v34
    v_dot2_f32_bf16 v34, v74, v23, v34
    v_dot2_f32_bf16 v34, v75, v24, v34
    s_waitcnt vmcnt(4)
    buffer_load_dwordx4 v[72:75], v20, s[4:7], s76 offen nt
    v_add_u32 v20, s9, v20
    v_dot2_f32_bf16 v35, v76, v21, 0
    v_dot2_f32_bf16 v35, v77, v22, v35
    v_dot2_f32_bf16 v35, v78, v23, v35
    v_dot2_f32_bf16 v35, v79, v24, v35
    s_waitcnt vmcnt(4)
    buffer_load_dwordx4 v[76:79], v20, s[4:7], s76 offen nt
    v_add_u32 v20, s11, v20
    v_dot2_f32_bf16 v36, v80, v21, 0
    v_dot2_f32_bf16 v36, v81, v22, v36
    v_dot2_f32_bf16 v36, v82, v23, v36
    v_dot2_f32_bf16 v36, v83, v24, v36
    s_waitcnt vmcnt(4)
    buffer_load_dwordx4 v[80:83], v20, s[4:7], s76 offen nt
    v_add_u32 v20, s9, v20
    v_dot2_f32_bf16 v37, v84, v21, 0
    v_dot2_f32_bf16 v37, v85, v22, v37
    v_dot2_f32_bf16 v37, v86, v23, v37
    v_dot2_f32_bf16 v37, v87, v24, v37
    s_waitcnt vmcnt(4)
    buffer_load_dwordx4 v[84:87], v20, s[4:7], s76 offen nt
    v_add_u32 v20, s10, v20
    v_dot2_f32_bf16 v38, v88, v21, 0
    v_dot2_f32_bf16 v38, v89, v22, v38
    v_dot2_f32_bf16 v38, v90, v23, v38
    v_dot2_f32_bf16 v38, v91, v24, v38
    s_waitcnt vmcnt(4)
    buffer_load_dwordx4 v[88:91], v20, s[4:7], s76 offen nt
    v_add_u32 v20, s9, v20
    v_dot2_f32_bf16 v39, v92, v21, 0
    v_dot2_f32_bf16 v39, v93, v22, v39
    v_dot2_f32_bf16 v39, v94, v23, v39
    v_dot2_f32_bf16 v39, v95, v24, v39
    s_waitcnt vmcnt(4)
    buffer_load_dwordx4 v[92:95], v20, s[4:7], s76 offen nt
    v_add_u32 v20, s12, v20
    v_and_b32 v20, 0xfffff, v20
    v_dot2_f32_bf16 v40, v96, v21, 0
    v_dot2_f32_bf16 v40, v97, v22, v40
    v_dot2_f32_bf16 v40, v98, v23, v40
    v_dot2_f32_bf16 v40, v99, v24, v40
    s_waitcnt vmcnt(4)
    buffer_load_dwordx4 v[96:99], v20, s[4:7], s76 offen nt
    v_add_u32 v20, s9, v20
    v_dot2_f32_bf16 v41, v100, v21, 0
    v_dot2_f32_bf16 v41, v101, v22, v41
    v_dot2_f32_bf16 v41, v102, v23, v41
    v_dot2_f32_bf16 v41, v103, v24, v41
    s_waitcnt vmcnt(4)
    buffer_load_dwordx4 v[100:103], v20, s[4:7], s76 offen nt
    v_add_u32 v20, s10, v20
    v_dot2_f32_bf16 v42, v104, v21, 0
    v_dot2_f32_bf16 v42, v105, v22, v42
    v_dot2_f32_bf16 v42, v106, v23, v42
    v_dot2_f32_bf16 v42, v107, v24, v42
    s_waitcnt vmcnt(4)
    buffer_load_dwordx4 v[104:107], v20, s[4:7], s76 offen nt
    v_add_u32 v20, s9, v20
    v_dot2_f32_bf16 v43, v108, v21, 0
    v_dot2_f32_bf16 v43, v109, v22, v43
    v_dot2_f32_bf16 v43, v110, v23, v43
    v_dot2_f32_bf16 v43, v111, v24, v43
    s_waitcnt vmcnt(4)
    buffer_load_dwordx4 v[108:111], v20, s[4:7], s76 offen nt
    v_add_u32 v20, s11, v20
    v_dot2_f32_bf16 v44, v112, v21, 0
    v_dot2_f32_bf16 v44, v113, v22, v44
    v_dot2_f32_bf16 v44, v114, v23, v44
    v_dot2_f32_bf16 v44, v115, v24, v44
    s_waitcnt vmcnt(4)
    buffer_load_dwordx4 v[112:115], v20, s[4:7], s76 offen nt
    v_add_u32 v20, s9, v20
    v_dot2_f32_bf16 v45, v116, v21, 0
    v_dot2_f32_bf16 v45, v117, v22, v45
    v_dot2_f32_bf16 v45, v118, v23, v45
    v_dot2_f32_bf16 v45, v119, v24, v45
    s_waitcnt vmcnt(4)
    buffer_load_dwordx4 v[116:119], v20, s[4:7], s76 offen nt
    v_add_u32 v20, s10, v20
    v_dot2_f32_bf16 v46, v120, v21, 0
    v_dot2_f32_bf16 v46, v121, v22, v46
    v_dot2_f32_bf16 v46, v122, v23, v46
    v_dot2_f32_bf16 v46, v123, v24, v46
    s_waitcnt vmcnt(4)
    buffer_load_dwordx4 v[120:123], v20, s[4:7], s76 offen nt
    v_add_u32 v20, s9, v20
    v_dot2_f32_bf16 v47, v124, v21, 0
    v_dot2_f32_bf16 v47, v125, v22, v47
    v_dot2_f32_bf16 v47, v126, v23, v47
    v_dot2_f32_bf16 v47, v127, v24, v47
    s_waitcnt vmcnt(4)
    buffer_load_dwordx4 v[124:127], v20, s[4:7], s76 offen nt
    v_add_u32 v20, s12, v20
    v_and_b32 v20, 0xfffff, v20
    v_add_f32_dpp v32, v32, v32 row_ror:8 row_mask:0xf bank_mask:0x3
    v_add_f32_dpp v33, v33, v33 row_ror:8 row_mask:0xf bank_mask:0x3
    v_add_f32_dpp v34, v34, v34 row_ror:8 row_mask:0xf bank_mask:0x3
    v_add_f32_dpp v35, v35, v35 row_ror:8 row_mask:0xf bank_mask:0x3
    v_add_f32_dpp v36, v36, v36 row_ror:8 row_mask:0xf bank_mask:0x3
    v_add_f32_dpp v37, v37, v37 row_ror:8 row_mask:0xf bank_mask:0x3
    v_add_f32_dpp v38, v38, v38 row_ror:8 row_mask:0xf bank_mask:0x3
    v_add_f32_dpp v39, v39, v39 row_ror:8 row_mask:0xf bank_mask:0x3
    v_add_f32_dpp v32, v40, v40 row_ror:8 row_mask:0xf bank_mask:0xc
    v_add_f32_dpp v33, v41, v41 row_ror:8 row_mask:0xf bank_mask:0xc
    v_add_f32_dpp v34, v42, v42 row_ror:8 row_mask:0xf bank_mask:0xc
    v_add_f32_dpp v35, v43, v43 row_ror:8 row_mask:0xf bank_mask:0xc
    v_add_f32_dpp v36, v44, v44 row_ror:8 row_mask:0xf bank_mask:0xc
    v_add_f32_dpp v37, v45, v45 row_ror:8 row_mask:0xf bank_mask:0xc
    v_add_f32_dpp v38, v46, v46 row_ror:8 row_mask:0xf bank_mask:0xc
    v_add_f32_dpp v39, v47, v47 row_ror:8 row_mask:0xf bank_mask:0xc
    v_add_f32_dpp v32, v32, v32 row_half_mirror row_mask:0xf bank_mask:0x5
    v_add_f32_dpp v33, v33, v33 row_half_mirror row_mask:0xf bank_mask:0x5
    v_add_f32_dpp v34, v34, v34 row_half_mirror row_mask:0xf bank_mask:0x5
    v_add_f32_dpp v35, v35, v35 row_half_mirror row_mask:0xf bank_mask:0x5
    v_add_f32_dpp v32, v36, v36 row_half_mirror row_mask:0xf bank_mask:0xa
    v_add_f32_dpp v33, v37, v37 row_half_mirror row_mask:0xf bank_mask:0xa
    v_add_f32_dpp v34, v38, v38 row_half_mirror row_mask:0xf bank_mask:0xa
    v_add_f32_dpp v35, v39, v39 row_half_mirror row_mask:0xf bank_mask:0xa
    v_add_f32_dpp v32, v32, v32 quad_perm:[1,0,3,2] row_mask:0xf bank_mask:0xf
    v_add_f32_dpp v33, v33, v33 quad_perm:[1,0,3,2] row_mask:0xf bank_mask:0xf
    v_add_f32_dpp v34, v34, v34 quad_perm:[1,0,3,2] row_mask:0xf bank_mask:0xf
    v_add_f32_dpp v35, v35, v35 quad_perm:[1,0,3,2] row_mask:0xf bank_mask:0xf
    v_cndmask_b32 v32, v32, v33, s[84:85]
    v_cndmask_b32 v34, v34, v35, s[84:85]
    s_nop 0
    v_add_f32_dpp v32, v32, v32 quad_perm:[2,3,0,1] row_mask:0xf bank_mask:0xf
    v_add_f32_dpp v34, v34, v34 quad_perm:[2,3,0,1] row_mask:0xf bank_mask:0xf
    v_cndmask_b32 v55, v32, v34, s[86:87]
    v_cvt_pk_bf16_f32 v55, v55, v55
    v_and_b32 v55, 0xffff0000, v55
    v_mul_f32 v55, s95, v55
    v_cvt_pk_bf16_f32 v55, v55, v55
    v_and_b32 v55, 0xffff0000, v55
    v_mov_b32 v48, v49
    v_mov_b32 v49, v50
    v_mov_b32 v50, v51
    v_mov_b32 v51, v52
    v_mov_b32 v52, v53
    v_mov_b32 v53, v54
    v_mov_b32 v54, v55
    s_cmp_lg_u32 s78, 0
    v_dot2_f32_bf16 v32, v128, v21, 0
    v_dot2_f32_bf16 v32, v129, v22, v32
    v_dot2_f32_bf16 v32, v130, v23, v32
    v_dot2_f32_bf16 v32, v131, v24, v32
    s_waitcnt vmcnt(4)
    buffer_load_dwordx4 v[128:131], v20, s[4:7], s76 offen nt
    v_add_u32 v20, s9, v20
    v_dot2_f32_bf16 v33, v132, v21, 0
    v_dot2_f32_bf16 v33, v133, v22, v33
    v_dot2_f32_bf16 v33, v134, v23, v33
    v_dot2_f32_bf16 v33, v135, v24, v33
    s_waitcnt vmcnt(4)
    buffer_load_dwordx4 v[132:135], v20, s[4:7], s76 offen nt
    v_add_u32 v20, s10, v20
    v_dot2_f32_bf16 v34, v136, v21, 0
    v_dot2_f32_bf16 v34, v137, v22, v34
    v_dot2_f32_bf16 v34, v138, v23, v34
    v_dot2_f32_bf16 v34, v139, v24, v34
    s_waitcnt vmcnt(4)
    buffer_load_dwordx4 v[136:139], v20, s[4:7], s76 offen nt
    v_add_u32 v20, s9, v20
    v_dot2_f32_bf16 v35, v140, v21, 0
    v_dot2_f32_bf16 v35, v141, v22, v35
    v_dot2_f32_bf16 v35, v142, v23, v35
    v_dot2_f32_bf16 v35, v143, v24, v35
    s_waitcnt vmcnt(4)
    buffer_load_dwordx4 v[140:143], v20, s[4:7], s76 offen nt
    v_add_u32 v20, s11, v20
    v_dot2_f32_bf16 v36, v144, v21, 0
    v_dot2_f32_bf16 v36, v145, v22, v36
    v_dot2_f32_bf16 v36, v146, v23, v36
    v_dot2_f32_bf16 v36, v147, v24, v36
    s_waitcnt vmcnt(4)
    buffer_load_dwordx4 v[144:147], v20, s[4:7], s76 offen nt
    v_add_u32 v20, s9, v20
    v_dot2_f32_bf16 v37, v148, v21, 0
    v_dot2_f32_bf16 v37, v149, v22, v37
    v_dot2_f32_bf16 v37, v150, v23, v37
    v_dot2_f32_bf16 v37, v151, v24, v37
    s_waitcnt vmcnt(4)
    buffer_load_dwordx4 v[148:151], v20, s[4:7], s76 offen nt
    v_add_u32 v20, s10, v20
    v_dot2_f32_bf16 v38, v152, v21, 0
    v_dot2_f32_bf16 v38, v153, v22, v38
    v_dot2_f32_bf16 v38, v154, v23, v38
    v_dot2_f32_bf16 v38, v155, v24, v38
    s_waitcnt vmcnt(4)
    buffer_load_dwordx4 v[152:155], v20, s[4:7], s76 offen nt
    v_add_u32 v20, s9, v20
    v_dot2_f32_bf16 v39, v156, v21, 0
    v_dot2_f32_bf16 v39, v157, v22, v39
    v_dot2_f32_bf16 v39, v158, v23, v39
    v_dot2_f32_bf16 v39, v159, v24, v39
    s_waitcnt vmcnt(4)
    buffer_load_dwordx4 v[156:159], v20, s[4:7], s76 offen nt
    v_add_u32 v20, s12, v20
    v_and_b32 v20, 0xfffff, v20
    v_dot2_f32_bf16 v40, v160, v21, 0
    v_dot2_f32_bf16 v40, v161, v22, v40
    v_dot2_f32_bf16 v40, v162, v23, v40
    v_dot2_f32_bf16 v40, v163, v24, v40
    s_waitcnt vmcnt(4)
    buffer_load_dwordx4 v[160:163], v20, s[4:7], s76 offen nt
    v_add_u32 v20, s9, v20
    v_dot2_f32_bf16 v41, v164, v21, 0
    v_dot2_f32_bf16 v41, v165, v22, v41
    v_dot2_f32_bf16 v41, v166, v23, v41
    v_dot2_f32_bf16 v41, v167, v24, v41
    s_waitcnt vmcnt(4)
    buffer_load_dwordx4 v[164:167], v20, s[4:7], s76 offen nt
    v_add_u32 v20, s10, v20
    v_dot2_f32_bf16 v42, v168, v21, 0
    v_dot2_f32_bf16 v42, v169, v22, v42
    v_dot2_f32_bf16 v42, v170, v23, v42
    v_dot2_f32_bf16 v42, v171, v24, v42
    s_waitcnt vmcnt(4)
    buffer_load_dwordx4 v[168:171], v20, s[4:7], s76 offen nt
    v_add_u32 v20, s9, v20
    v_dot2_f32_bf16 v43, v172, v21, 0
    v_dot2_f32_bf16 v43, v173, v22, v43
    v_dot2_f32_bf16 v43, v174, v23, v43
    v_dot2_f32_bf16 v43, v175, v24, v43
    s_waitcnt vmcnt(4)
    buffer_load_dwordx4 v[172:175], v20, s[4:7], s76 offen nt
    v_add_u32 v20, s11, v20
    v_dot2_f32_bf16 v44, v176, v21, 0
    v_dot2_f32_bf16 v44, v177, v22, v44
    v_dot2_f32_bf16 v44, v178, v23, v44
    v_dot2_f32_bf16 v44, v179, v24, v44
    s_waitcnt vmcnt(4)
    buffer_load_dwordx4 v[176:179], v20, s[4:7], s76 offen nt
    v_add_u32 v20, s9, v20
    v_dot2_f32_bf16 v45, v180, v21, 0
    v_dot2_f32_bf16 v45, v181, v22, v45
    v_dot2_f32_bf16 v45, v182, v23, v45
    v_dot2_f32_bf16 v45, v183, v24, v45
    s_waitcnt vmcnt(4)
    buffer_load_dwordx4 v[180:183], v20, s[4:7], s76 offen nt
    v_add_u32 v20, s10, v20
    v_dot2_f32_bf16 v46, v184, v21, 0
    v_dot2_f32_bf16 v46, v185, v22, v46
    v_dot2_f32_bf16 v46, v186, v23, v46
    v_dot2_f32_bf16 v46, v187, v24, v46
    s_waitcnt vmcnt(4)
    buffer_load_dwordx4 v[184:187], v20, s[4:7], s76 offen nt
    v_add_u32 v20, s9, v20
    v_dot2_f32_bf16 v47, v188, v21, 0
    v_dot2_f32_bf16 v47, v189, v22, v47
    v_dot2_f32_bf16 v47, v190, v23, v47
    v_dot2_f32_bf16 v47, v191, v24, v47
    s_waitcnt vmcnt(4)
    buffer_load_dwordx4 v[188:191], v20, s[4:7], s76 offen nt
    v_add_u32 v20, s12, v20
    v_and_b32 v20, 0xfffff, v20
    v_add_f32_dpp v32, v32, v32 row_ror:8 row_mask:0xf bank_mask:0x3
    v_add_f32_dpp v33, v33, v33 row_ror:8 row_mask:0xf bank_mask:0x3
    v_add_f32_dpp v34, v34, v34 row_ror:8 row_mask:0xf bank_mask:0x3
    v_add_f32_dpp v35, v35, v35 row_ror:8 row_mask:0xf bank_mask:0x3
    v_add_f32_dpp v36, v36, v36 row_ror:8 row_mask:0xf bank_mask:0x3
    v_add_f32_dpp v37, v37, v37 row_ror:8 row_mask:0xf bank_mask:0x3
    v_add_f32_dpp v38, v38, v38 row_ror:8 row_mask:0xf bank_mask:0x3
    v_add_f32_dpp v39, v39, v39 row_ror:8 row_mask:0xf bank_mask:0x3
    v_add_f32_dpp v32, v40, v40 row_ror:8 row_mask:0xf bank_mask:0xc
    v_add_f32_dpp v33, v41, v41 row_ror:8 row_mask:0xf bank_mask:0xc
    v_add_f32_dpp v34, v42, v42 row_ror:8 row_mask:0xf bank_mask:0xc
    v_add_f32_dpp v35, v43, v43 row_ror:8 row_mask:0xf bank_mask:0xc
    v_add_f32_dpp v36, v44, v44 row_ror:8 row_mask:0xf bank_mask:0xc
    v_add_f32_dpp v37, v45, v45 row_ror:8 row_mask:0xf bank_mask:0xc
    v_add_f32_dpp v38, v46, v46 row_ror:8 row_mask:0xf bank_mask:0xc
    v_add_f32_dpp v39, v47, v47 row_ror:8 row_mask:0xf bank_mask:0xc
    v_add_f32_dpp v32, v32, v32 row_half_mirror row_mask:0xf bank_mask:0x5
    v_add_f32_dpp v33, v33, v33 row_half_mirror row_mask:0xf bank_mask:0x5
    v_add_f32_dpp v34, v34, v34 row_half_mirror row_mask:0xf bank_mask:0x5
    v_add_f32_dpp v35, v35, v35 row_half_mirror row_mask:0xf bank_mask:0x5
    v_add_f32_dpp v32, v36, v36 row_half_mirror row_mask:0xf bank_mask:0xa
    v_add_f32_dpp v33, v37, v37 row_half_mirror row_mask:0xf bank_mask:0xa
    v_add_f32_dpp v34, v38, v38 row_half_mirror row_mask:0xf bank_mask:0xa
    v_add_f32_dpp v35, v39, v39 row_half_mirror row_mask:0xf bank_mask:0xa
    v_add_f32_dpp v32, v32, v32 quad_perm:[1,0,3,2] row_mask:0xf bank_mask:0xf
    v_add_f32_dpp v33, v33, v33 quad_perm:[1,0,3,2] row_mask:0xf bank_mask:0xf
    v_add_f32_dpp v34, v34, v34 quad_perm:[1,0,3,2] row_mask:0xf bank_mask:0xf
    v_add_f32_dpp v35, v35, v35 quad_perm:[1,0,3,2] row_mask:0xf bank_mask:0xf
    v_cndmask_b32 v32, v32, v33, s[84:85]
    v_cndmask_b32 v34, v34, v35, s[84:85]
    s_nop 0
    v_add_f32_dpp v32, v32, v32 quad_perm:[2,3,0,1] row_mask:0xf bank_mask:0xf
    v_add_f32_dpp v34, v34, v34 quad_perm:[2,3,0,1] row_mask:0xf bank_mask:0xf
    v_cndmask_b32 v55, v32, v34, s[86:87]
    v_cvt_pk_bf16_f32 v55, v55, v55
    v_and_b32 v55, 0xffff0000, v55
    v_mul_f32 v55, s95, v55
    v_cvt_pk_bf16_f32 v55, v55, v55
    v_and_b32 v55, 0xffff0000, v55
    s_cmp_eq_u32 s8, 2
    s_cbranch_scc1 L_kdone
L_kentry:
    s_cmp_eq_u32 s8, 1
    s_cselect_b32 s4, s52, s4
    s_cselect_b32 s5, s53, s5
    s_cselect_b32 s80, 524288, 0
    s_add_u32 s8, s8, 1
    v_mov_b32 v48, v49
    v_mov_b32 v49, v50
    v_mov_b32 v50, v51
    v_mov_b32 v51, v52
    v_mov_b32 v52, v53
    v_mov_b32 v53, v54
    v_mov_b32 v54, v55
    s_cmp_lg_u32 s78, 0
    v_dot2_f32_bf16 v32, v192, v21, 0
    v_dot2_f32_bf16 v32, v193, v22, v32
    v_dot2_f32_bf16 v32, v194, v23, v32
    v_dot2_f32_bf16 v32, v195, v24, v32
    s_waitcnt vmcnt(4)
    buffer_load_dwordx4 v[192:195], v20, s[4:7], s76 offen nt
    v_add_u32 v20, s9, v20
    v_dot2_f32_bf16 v33, v196, v21, 0
    v_dot2_f32_bf16 v33, v197, v22, v33
    v_dot2_f32_bf16 v33, v198, v23, v33
    v_dot2_f32_bf16 v33, v199, v24, v33
    s_waitcnt vmcnt(4)
    buffer_load_dwordx4 v[196:199], v20, s[4:7], s76 offen nt
    v_add_u32 v20, s10, v20
    v_dot2_f32_bf16 v34, v200, v21, 0
    v_dot2_f32_bf16 v34, v201, v22, v34
    v_dot2_f32_bf16 v34, v202, v23, v34
    v_dot2_f32_bf16 v34, v203, v24, v34
    s_waitcnt vmcnt(4)
    buffer_load_dwordx4 v[200:203], v20, s[4:7], s76 offen nt
    v_add_u32 v20, s9, v20
    v_dot2_f32_bf16 v35, v204, v21, 0
    v_dot2_f32_bf16 v35, v205, v22, v35
    v_dot2_f32_bf16 v35, v206, v23, v35
    v_dot2_f32_bf16 v35, v207, v24, v35
    s_waitcnt vmcnt(4)
    buffer_load_dwordx4 v[204:207], v20, s[4:7], s76 offen nt
    v_add_u32 v20, s11, v20
    v_dot2_f32_bf16 v36, v208, v21, 0
    v_dot2_f32_bf16 v36, v209, v22, v36
    v_dot2_f32_bf16 v36, v210, v23, v36
    v_dot2_f32_bf16 v36, v211, v24, v36
    s_waitcnt vmcnt(4)
    buffer_load_dwordx4 v[208:211], v20, s[4:7], s76 offen nt
    v_add_u32 v20, s9, v20
    v_dot2_f32_bf16 v37, v212, v21, 0
    v_dot2_f32_bf16 v37, v213, v22, v37
    v_dot2_f32_bf16 v37, v214, v23, v37
    v_dot2_f32_bf16 v37, v215, v24, v37
    s_waitcnt vmcnt(4)
    buffer_load_dwordx4 v[212:215], v20, s[4:7], s76 offen nt
    v_add_u32 v20, s10, v20
    v_dot2_f32_bf16 v38, v216, v21, 0
    v_dot2_f32_bf16 v38, v217, v22, v38
    v_dot2_f32_bf16 v38, v218, v23, v38
    v_dot2_f32_bf16 v38, v219, v24, v38
    s_waitcnt vmcnt(4)
    buffer_load_dwordx4 v[216:219], v20, s[4:7], s76 offen nt
    v_add_u32 v20, s9, v20
    v_dot2_f32_bf16 v39, v220, v21, 0
    v_dot2_f32_bf16 v39, v221, v22, v39
    v_dot2_f32_bf16 v39, v222, v23, v39
    v_dot2_f32_bf16 v39, v223, v24, v39
    s_waitcnt vmcnt(4)
    buffer_load_dwordx4 v[220:223], v20, s[4:7], s76 offen nt
    v_add_u32 v20, s12, v20
    v_and_b32 v20, 0xfffff, v20
    v_dot2_f32_bf16 v40, v224, v21, 0
    v_dot2_f32_bf16 v40, v225, v22, v40
    v_dot2_f32_bf16 v40, v226, v23, v40
    v_dot2_f32_bf16 v40, v227, v24, v40
    s_waitcnt vmcnt(4)
    buffer_load_dwordx4 v[224:227], v20, s[4:7], s76 offen nt
    v_add_u32 v20, s9, v20
    v_dot2_f32_bf16 v41, v228, v21, 0
    v_dot2_f32_bf16 v41, v229, v22, v41
    v_dot2_f32_bf16 v41, v230, v23, v41
    v_dot2_f32_bf16 v41, v231, v24, v41
    s_waitcnt vmcnt(4)
    buffer_load_dwordx4 v[228:231], v20, s[4:7], s76 offen nt
    v_add_u32 v20, s10, v20
    v_dot2_f32_bf16 v42, v232, v21, 0
    v_dot2_f32_bf16 v42, v233, v22, v42
    v_dot2_f32_bf16 v42, v234, v23, v42
    v_dot2_f32_bf16 v42, v235, v24, v42
    s_waitcnt vmcnt(4)
    buffer_load_dwordx4 v[232:235], v20, s[4:7], s76 offen nt
    v_add_u32 v20, s9, v20
    v_dot2_f32_bf16 v43, v236, v21, 0
    v_dot2_f32_bf16 v43, v237, v22, v43
    v_dot2_f32_bf16 v43, v238, v23, v43
    v_dot2_f32_bf16 v43, v239, v24, v43
    s_waitcnt vmcnt(4)
    buffer_load_dwordx4 v[236:239], v20, s[4:7], s76 offen nt
    v_add_u32 v20, s11, v20
    v_dot2_f32_bf16 v44, v240, v21, 0
    v_dot2_f32_bf16 v44, v241, v22, v44
    v_dot2_f32_bf16 v44, v242, v23, v44
    v_dot2_f32_bf16 v44, v243, v24, v44
    s_waitcnt vmcnt(4)
    buffer_load_dwordx4 v[240:243], v20, s[4:7], s76 offen nt
    v_add_u32 v20, s9, v20
    v_dot2_f32_bf16 v45, v244, v21, 0
    v_dot2_f32_bf16 v45, v245, v22, v45
    v_dot2_f32_bf16 v45, v246, v23, v45
    v_dot2_f32_bf16 v45, v247, v24, v45
    s_waitcnt vmcnt(4)
    buffer_load_dwordx4 v[244:247], v20, s[4:7], s76 offen nt
    v_add_u32 v20, s10, v20
    v_dot2_f32_bf16 v46, v248, v21, 0
    v_dot2_f32_bf16 v46, v249, v22, v46
    v_dot2_f32_bf16 v46, v250, v23, v46
    v_dot2_f32_bf16 v46, v251, v24, v46
    s_waitcnt vmcnt(4)
    buffer_load_dwordx4 v[248:251], v20, s[4:7], s76 offen nt
    v_add_u32 v20, s9, v20
    v_dot2_f32_bf16 v47, v252, v21, 0
    v_dot2_f32_bf16 v47, v253, v22, v47
    v_dot2_f32_bf16 v47, v254, v23, v47
    v_dot2_f32_bf16 v47, v255, v24, v47
    s_waitcnt vmcnt(4)
    buffer_load_dwordx4 v[252:255], v20, s[4:7], s76 offen nt
    v_add_u32 v20, s12, v20
    v_and_b32 v20, 0xfffff, v20
    v_add_f32_dpp v32, v32, v32 row_ror:8 row_mask:0xf bank_mask:0x3
    v_add_f32_dpp v33, v33, v33 row_ror:8 row_mask:0xf bank_mask:0x3
    v_add_f32_dpp v34, v34, v34 row_ror:8 row_mask:0xf bank_mask:0x3
    v_add_f32_dpp v35, v35, v35 row_ror:8 row_mask:0xf bank_mask:0x3
    v_add_f32_dpp v36, v36, v36 row_ror:8 row_mask:0xf bank_mask:0x3
    v_add_f32_dpp v37, v37, v37 row_ror:8 row_mask:0xf bank_mask:0x3
    v_add_f32_dpp v38, v38, v38 row_ror:8 row_mask:0xf bank_mask:0x3
    v_add_f32_dpp v39, v39, v39 row_ror:8 row_mask:0xf bank_mask:0x3
    v_add_f32_dpp v32, v40, v40 row_ror:8 row_mask:0xf bank_mask:0xc
    v_add_f32_dpp v33, v41, v41 row_ror:8 row_mask:0xf bank_mask:0xc
    v_add_f32_dpp v34, v42, v42 row_ror:8 row_mask:0xf bank_mask:0xc
    v_add_f32_dpp v35, v43, v43 row_ror:8 row_mask:0xf bank_mask:0xc
    v_add_f32_dpp v36, v44, v44 row_ror:8 row_mask:0xf bank_mask:0xc
    v_add_f32_dpp v37, v45, v45 row_ror:8 row_mask:0xf bank_mask:0xc
    v_add_f32_dpp v38, v46, v46 row_ror:8 row_mask:0xf bank_mask:0xc
    v_add_f32_dpp v39, v47, v47 row_ror:8 row_mask:0xf bank_mask:0xc
    v_add_f32_dpp v32, v32, v32 row_half_mirror row_mask:0xf bank_mask:0x5
    v_add_f32_dpp v33, v33, v33 row_half_mirror row_mask:0xf bank_mask:0x5
    v_add_f32_dpp v34, v34, v34 row_half_mirror row_mask:0xf bank_mask:0x5
    v_add_f32_dpp v35, v35, v35 row_half_mirror row_mask:0xf bank_mask:0x5
    v_add_f32_dpp v32, v36, v36 row_half_mirror row_mask:0xf bank_mask:0xa
    v_add_f32_dpp v33, v37, v37 row_half_mirror row_mask:0xf bank_mask:0xa
    v_add_f32_dpp v34, v38, v38 row_half_mirror row_mask:0xf bank_mask:0xa
    v_add_f32_dpp v35, v39, v39 row_half_mirror row_mask:0xf bank_mask:0xa
    v_add_f32_dpp v32, v32, v32 quad_perm:[1,0,3,2] row_mask:0xf bank_mask:0xf
    v_add_f32_dpp v33, v33, v33 quad_perm:[1,0,3,2] row_mask:0xf bank_mask:0xf
    v_add_f32_dpp v34, v34, v34 quad_perm:[1,0,3,2] row_mask:0xf bank_mask:0xf
    v_add_f32_dpp v35, v35, v35 quad_perm:[1,0,3,2] row_mask:0xf bank_mask:0xf
    v_cndmask_b32 v32, v32, v33, s[84:85]
    v_cndmask_b32 v34, v34, v35, s[84:85]
    s_nop 0
    v_add_f32_dpp v32, v32, v32 quad_perm:[2,3,0,1] row_mask:0xf bank_mask:0xf
    v_add_f32_dpp v34, v34, v34 quad_perm:[2,3,0,1] row_mask:0xf bank_mask:0xf
    v_cndmask_b32 v55, v32, v34, s[86:87]
    v_cvt_pk_bf16_f32 v55, v55, v55
    v_and_b32 v55, 0xffff0000, v55
    v_mul_f32 v55, s95, v55
    v_cvt_pk_bf16_f32 v55, v55, v55
    v_and_b32 v55, 0xffff0000, v55
    s_branch L_kloop
L_kdone:
    v_max3_f32 v26, v48, v49, v50
    v_max3_f32 v32, v51, v52, v53
    v_max3_f32 v26, v26, v54, v55
    v_max_f32 v26, v26, v32
    s_nop 1
    v_max_f32_dpp v26, v26, v26 row_ror:8 row_mask:0xf bank_mask:0xf
    s_nop 1
    v_max_f32_dpp v26, v26, v26 row_ror:4 row_mask:0xf bank_mask:0xf
    s_nop 1
    v_max_f32_dpp v26, v26, v26 row_ror:2 row_mask:0xf bank_mask:0xf
    s_nop 1
    v_max_f32_dpp v26, v26, v26 row_ror:1 row_mask:0xf bank_mask:0xf
    v_mov_b32 v32, v26
    s_nop 1
    v_permlane16_swap_b32 v26, v32
    v_max_f32 v26, v26, v32
    v_mov_b32 v32, v26
    s_nop 1
    v_permlane32_swap_b32 v26, v32
    v_max_f32 v26, v26, v32
    v_sub_f32 v48, v48, v26
    v_sub_f32 v49, v49, v26
    v_sub_f32 v50, v50, v26
    v_sub_f32 v51, v51, v26
    v_sub_f32 v52, v52, v26
    v_sub_f32 v53, v53, v26
    v_sub_f32 v54, v54, v26
    v_sub_f32 v55, v55, v26
    v_mul_f32 v48, s94, v48
    v_mul_f32 v49, s94, v49
    v_mul_f32 v50, s94, v50
    v_mul_f32 v51, s94, v51
    v_mul_f32 v52, s94, v52
    v_mul_f32 v53, s94, v53
    v_mul_f32 v54, s94, v54
    v_mul_f32 v55, s94, v55
    v_exp_f32 v48, v48
    v_exp_f32 v49, v49
    v_exp_f32 v50, v50
    v_exp_f32 v51, v51
    v_exp_f32 v52, v52
    v_exp_f32 v53, v53
    v_exp_f32 v54, v54
    v_exp_f32 v55, v55
    v_pk_add_f32 v[32:33], v[48:49], v[50:51]
    v_pk_add_f32 v[34:35], v[52:53], v[54:55]
    v_pk_add_f32 v[32:33], v[32:33], v[34:35]
    v_add_f32 v27, v32, v33
    v_cvt_pk_bf16_f32 v48, v48, v48
    v_cvt_pk_bf16_f32 v49, v49, v49
    v_cvt_pk_bf16_f32 v50, v50, v50
    v_cvt_pk_bf16_f32 v51, v51, v51
    v_cvt_pk_bf16_f32 v52, v52, v52
    v_cvt_pk_bf16_f32 v53, v53, v53
    v_cvt_pk_bf16_f32 v54, v54, v54
    v_cvt_pk_bf16_f32 v55, v55, v55
    v_mov_b32 v8, 0
    v_mov_b32 v9, 0
    v_mov_b32 v10, 0
    v_mov_b32 v11, 0
    s_mov_b32 s8, 0
    v_and_b32_dpp v12, v48, v2 row_newbcast:0 row_mask:0xf bank_mask:0xf
    v_and_b32_dpp v13, v48, v3 row_newbcast:0 row_mask:0xf bank_mask:0xf
    v_and_b32_dpp v14, v48, v4 row_newbcast:0 row_mask:0xf bank_mask:0xf
    v_and_b32_dpp v15, v48, v5 row_newbcast:0 row_mask:0xf bank_mask:0xf
    v_add_f32_dpp v27, v27, v27 row_ror:8 row_mask:0xf bank_mask:0xf
    s_nop 1
    v_add_f32_dpp v27, v27, v27 row_ror:4 row_mask:0xf bank_mask:0xf
    s_nop 1
    v_add_f32_dpp v27, v27, v27 row_ror:2 row_mask:0xf bank_mask:0xf
    s_nop 1
    v_add_f32_dpp v27, v27, v27 row_ror:1 row_mask:0xf bank_mask:0xf
    v_mov_b32 v34, v27
    s_nop 1
    v_permlane16_swap_b32 v27, v34
    v_add_f32 v27, v27, v34
    v_mov_b32 v34, v27
    s_nop 1
    v_permlane32_swap_b32 v27, v34
    v_add_f32 v27, v27, v34
    v_min_u32 v26, -2, v26
    v_min_u32 v27, -2, v27
    s_lshl_b32 s83, s72, 3
    v_mov_b32 v1, s83
    ds_write_b64 v1, v[26:27] offset:7168
    v_mov_b32 v33, 0
    s_branch L_ventry
.p2align 6
L_vloop:
    s_cmp_ge_u32 s8, 3
    s_cselect_b32 s80, 0, -1
    v_mov_b32 v32, s80
    ds_write_b32 v33, v32 offset:7200
    s_cmp_ge_u32 s8, 5
    s_cselect_b64 vcc, -1, 0
    s_add_u32 s8, s8, 1
    ds_read_b32 v35, v33 offset:7212
    s_waitcnt lgkmcnt(0)
    v_readfirstlane_b32 s81, v35
    s_nop 1
    s_min_u32 s81, s81, 4
    s_cmp_gt_u32 s8, s81
    v_and_b32_dpp v16, v48, v2 row_newbcast:1 row_mask:0xf bank_mask:0xf
    v_and_b32_dpp v17, v48, v3 row_newbcast:1 row_mask:0xf bank_mask:0xf
    v_and_b32_dpp v18, v48, v4 row_newbcast:1 row_mask:0xf bank_mask:0xf
    v_and_b32_dpp v19, v48, v5 row_newbcast:1 row_mask:0xf bank_mask:0xf
    s_cbranch_vccz L_vw0
    s_waitcnt vmcnt(15)
L_vw0:
    v_mfma_f32_16x16x32_bf16 v[8:11], v[64:67], v[12:15], v[8:11]
    v_and_b32_dpp v12, v48, v2 row_newbcast:2 row_mask:0xf bank_mask:0xf
    v_and_b32_dpp v13, v48, v3 row_newbcast:2 row_mask:0xf bank_mask:0xf
    v_and_b32_dpp v14, v48, v4 row_newbcast:2 row_mask:0xf bank_mask:0xf
    v_and_b32_dpp v15, v48, v5 row_newbcast:2 row_mask:0xf bank_mask:0xf
    s_cbranch_vccz L_vw1
    s_waitcnt vmcnt(14)
L_vw1:
    v_mfma_f32_16x16x32_bf16 v[8:11], v[68:71], v[16:19], v[8:11]
    v_and_b32_dpp v16, v48, v2 row_newbcast:3 row_mask:0xf bank_mask:0xf
    v_and_b32_dpp v17, v48, v3 row_newbcast:3 row_mask:0xf bank_mask:0xf
    v_and_b32_dpp v18, v48, v4 row_newbcast:3 row_mask:0xf bank_mask:0xf
    v_and_b32_dpp v19, v48, v5 row_newbcast:3 row_mask:0xf bank_mask:0xf
    s_cbranch_vccz L_vw2
    s_waitcnt vmcnt(13)
L_vw2:
    v_mfma_f32_16x16x32_bf16 v[8:11], v[72:75], v[12:15], v[8:11]
    v_and_b32_dpp v12, v48, v2 row_newbcast:4 row_mask:0xf bank_mask:0xf
    v_and_b32_dpp v13, v48, v3 row_newbcast:4 row_mask:0xf bank_mask:0xf
    v_and_b32_dpp v14, v48, v4 row_newbcast:4 row_mask:0xf bank_mask:0xf
    v_and_b32_dpp v15, v48, v5 row_newbcast:4 row_mask:0xf bank_mask:0xf
    s_cbranch_vccz L_vw3
    s_waitcnt vmcnt(12)
L_vw3:
    v_mfma_f32_16x16x32_bf16 v[8:11], v[76:79], v[16:19], v[8:11]
    v_and_b32_dpp v16, v48, v2 row_newbcast:5 row_mask:0xf bank_mask:0xf
    v_and_b32_dpp v17, v48, v3 row_newbcast:5 row_mask:0xf bank_mask:0xf
    v_and_b32_dpp v18, v48, v4 row_newbcast:5 row_mask:0xf bank_mask:0xf
    v_and_b32_dpp v19, v48, v5 row_newbcast:5 row_mask:0xf bank_mask:0xf
    s_cbranch_vccz L_vw4
    s_waitcnt vmcnt(11)
L_vw4:
    v_mfma_f32_16x16x32_bf16 v[8:11], v[80:83], v[12:15], v[8:11]
    v_and_b32_dpp v12, v48, v2 row_newbcast:6 row_mask:0xf bank_mask:0xf
    v_and_b32_dpp v13, v48, v3 row_newbcast:6 row_mask:0xf bank_mask:0xf
    v_and_b32_dpp v14, v48, v4 row_newbcast:6 row_mask:0xf bank_mask:0xf
    v_and_b32_dpp v15, v48, v5 row_newbcast:6 row_mask:0xf bank_mask:0xf
    s_cbranch_vccz L_vw5
    s_waitcnt vmcnt(10)
L_vw5:
    v_mfma_f32_16x16x32_bf16 v[8:11], v[84:87], v[16:19], v[8:11]
    v_and_b32_dpp v16, v48, v2 row_newbcast:7 row_mask:0xf bank_mask:0xf
    v_and_b32_dpp v17, v48, v3 row_newbcast:7 row_mask:0xf bank_mask:0xf
    v_and_b32_dpp v18, v48, v4 row_newbcast:7 row_mask:0xf bank_mask:0xf
    v_and_b32_dpp v19, v48, v5 row_newbcast:7 row_mask:0xf bank_mask:0xf
    s_cbranch_vccz L_vw6
    s_waitcnt vmcnt(9)
L_vw6:
    v_mfma_f32_16x16x32_bf16 v[8:11], v[88:91], v[12:15], v[8:11]
    v_and_b32_dpp v12, v48, v2 row_newbcast:8 row_mask:0xf bank_mask:0xf
    v_and_b32_dpp v13, v48, v3 row_newbcast:8 row_mask:0xf bank_mask:0xf
    v_and_b32_dpp v14, v48, v4 row_newbcast:8 row_mask:0xf bank_mask:0xf
    v_and_b32_dpp v15, v48, v5 row_newbcast:8 row_mask:0xf bank_mask:0xf
    s_cbranch_vccz L_vw7
    s_waitcnt vmcnt(8)
L_vw7:
    v_mfma_f32_16x16x32_bf16 v[8:11], v[92:95], v[16:19], v[8:11]
    s_cbranch_vccnz L_vs7
    s_waitcnt vmcnt(15)
    s_cbranch_scc1 L_pw65
    s_waitcnt vmcnt(4)
L_pw65:
    buffer_load_dwordx4 v[64:67], v20, s[4:7], s76 offen nt
    v_add_u32 v20, s9, v20
    s_waitcnt vmcnt(15)
    s_cbranch_scc1 L_pw66
    s_waitcnt vmcnt(4)
L_pw66:
    buffer_load_dwordx4 v[68:71], v20, s[4:7], s76 offen nt
    v_add_u32 v20, s10, v20
    s_waitcnt vmcnt(15)
    s_cbranch_scc1 L_pw67
    s_waitcnt vmcnt(4)
L_pw67:
    buffer_load_dwordx4 v[72:75], v20, s[4:7], s76 offen nt
    v_add_u32 v20, s9, v20
    s_waitcnt vmcnt(15)
    s_cbranch_scc1 L_pw68
    s_waitcnt vmcnt(4)
L_pw68:
    buffer_load_dwordx4 v[76:79], v20, s[4:7], s76 offen nt
    v_add_u32 v20, s11, v20
    s_waitcnt vmcnt(15)
    s_cbranch_scc1 L_pw69
    s_waitcnt vmcnt(4)
L_pw69:
    buffer_load_dwordx4 v[80:83], v20, s[4:7], s76 offen nt
    v_add_u32 v20, s9, v20
    s_waitcnt vmcnt(15)
    s_cbranch_scc1 L_pw70
    s_waitcnt vmcnt(4)
L_pw70:
    buffer_load_dwordx4 v[84:87], v20, s[4:7], s76 offen nt
    v_add_u32 v20, s10, v20
    s_waitcnt vmcnt(15)
    s_cbranch_scc1 L_pw71
    s_waitcnt vmcnt(4)
L_pw71:
    buffer_load_dwordx4 v[88:91], v20, s[4:7], s76 offen nt
    v_add_u32 v20, s9, v20
    s_waitcnt vmcnt(15)
    s_cbranch_scc1 L_pw72
    s_waitcnt vmcnt(4)
L_pw72:
    buffer_load_dwordx4 v[92:95], v20, s[4:7], s76 offen nt
    v_add_u32 v20, s12, v20
    v_and_b32 v20, 0xfffff, v20
L_vs7:
    v_and_b32_dpp v16, v48, v2 row_newbcast:9 row_mask:0xf bank_mask:0xf
    v_and_b32_dpp v17, v48, v3 row_newbcast:9 row_mask:0xf bank_mask:0xf
    v_and_b32_dpp v18, v48, v4 row_newbcast:9 row_mask:0xf bank_mask:0xf
    v_and_b32_dpp v19, v48, v5 row_newbcast:9 row_mask:0xf bank_mask:0xf
    s_cbranch_vccz L_vw8
    s_waitcnt vmcnt(7)
L_vw8:
    v_mfma_f32_16x16x32_bf16 v[8:11], v[96:99], v[12:15], v[8:11]
    v_and_b32_dpp v12, v48, v2 row_newbcast:10 row_mask:0xf bank_mask:0xf
    v_and_b32_dpp v13, v48, v3 row_newbcast:10 row_mask:0xf bank_mask:0xf
    v_and_b32_dpp v14, v48, v4 row_newbcast:10 row_mask:0xf bank_mask:0xf
    v_and_b32_dpp v15, v48, v5 row_newbcast:10 row_mask:0xf bank_mask:0xf
    s_cbranch_vccz L_vw9
    s_waitcnt vmcnt(6)
L_vw9:
    v_mfma_f32_16x16x32_bf16 v[8:11], v[100:103], v[16:19], v[8:11]
    v_and_b32_dpp v16, v48, v2 row_newbcast:11 row_mask:0xf bank_mask:0xf
    v_and_b32_dpp v17, v48, v3 row_newbcast:11 row_mask:0xf bank_mask:0xf
    v_and_b32_dpp v18, v48, v4 row_newbcast:11 row_mask:0xf bank_mask:0xf
    v_and_b32_dpp v19, v48, v5 row_newbcast:11 row_mask:0xf bank_mask:0xf
    s_cbranch_vccz L_vw10
    s_waitcnt vmcnt(5)
L_vw10:
    v_mfma_f32_16x16x32_bf16 v[8:11], v[104:107], v[12:15], v[8:11]
    v_and_b32_dpp v12, v48, v2 row_newbcast:12 row_mask:0xf bank_mask:0xf
    v_and_b32_dpp v13, v48, v3 row_newbcast:12 row_mask:0xf bank_mask:0xf
    v_and_b32_dpp v14, v48, v4 row_newbcast:12 row_mask:0xf bank_mask:0xf
    v_and_b32_dpp v15, v48, v5 row_newbcast:12 row_mask:0xf bank_mask:0xf
    s_cbranch_vccz L_vw11
    s_waitcnt vmcnt(4)
L_vw11:
    v_mfma_f32_16x16x32_bf16 v[8:11], v[108:111], v[16:19], v[8:11]
    v_and_b32_dpp v16, v48, v2 row_newbcast:13 row_mask:0xf bank_mask:0xf
    v_and_b32_dpp v17, v48, v3 row_newbcast:13 row_mask:0xf bank_mask:0xf
    v_and_b32_dpp v18, v48, v4 row_newbcast:13 row_mask:0xf bank_mask:0xf
    v_and_b32_dpp v19, v48, v5 row_newbcast:13 row_mask:0xf bank_mask:0xf
    s_cbranch_vccz L_vw12
    s_waitcnt vmcnt(3)
L_vw12:
    v_mfma_f32_16x16x32_bf16 v[8:11], v[112:115], v[12:15], v[8:11]
    v_and_b32_dpp v12, v48, v2 row_newbcast:14 row_mask:0xf bank_mask:0xf
    v_and_b32_dpp v13, v48, v3 row_newbcast:14 row_mask:0xf bank_mask:0xf
    v_and_b32_dpp v14, v48, v4 row_newbcast:14 row_mask:0xf bank_mask:0xf
    v_and_b32_dpp v15, v48, v5 row_newbcast:14 row_mask:0xf bank_mask:0xf
    s_cbranch_vccz L_vw13
    s_waitcnt vmcnt(2)
L_vw13:
    v_mfma_f32_16x16x32_bf16 v[8:11], v[116:119], v[16:19], v[8:11]
    v_and_b32_dpp v16, v48, v2 row_newbcast:15 row_mask:0xf bank_mask:0xf
    v_and_b32_dpp v17, v48, v3 row_newbcast:15 row_mask:0xf bank_mask:0xf
    v_and_b32_dpp v18, v48, v4 row_newbcast:15 row_mask:0xf bank_mask:0xf
    v_and_b32_dpp v19, v48, v5 row_newbcast:15 row_mask:0xf bank_mask:0xf
    s_cbranch_vccz L_vw14
    s_waitcnt vmcnt(1)
L_vw14:
    v_mfma_f32_16x16x32_bf16 v[8:11], v[120:123], v[12:15], v[8:11]
    v_and_b32_dpp v12, v49, v2 row_newbcast:0 row_mask:0xf bank_mask:0xf
    v_and_b32_dpp v13, v49, v3 row_newbcast:0 row_mask:0xf bank_mask:0xf
    v_and_b32_dpp v14, v49, v4 row_newbcast:0 row_mask:0xf bank_mask:0xf
    v_and_b32_dpp v15, v49, v5 row_newbcast:0 row_mask:0xf bank_mask:0xf
    s_cbranch_vccz L_vw15
    s_waitcnt vmcnt(0)
L_vw15:
    v_mfma_f32_16x16x32_bf16 v[8:11], v[124:127], v[16:19], v[8:11]
    s_cbranch_vccnz L_vs15
    s_waitcnt vmcnt(15)
    s_cbranch_scc1 L_pw73
    s_waitcnt vmcnt(4)
L_pw73:
    buffer_load_dwordx4 v[96:99], v20, s[4:7], s76 offen nt
    v_add_u32 v20, s9, v20
    s_waitcnt vmcnt(15)
    s_cbranch_scc1 L_pw74
    s_waitcnt vmcnt(4)
L_pw74:
    buffer_load_dwordx4 v[100:103], v20, s[4:7], s76 offen nt
    v_add_u32 v20, s10, v20
    s_waitcnt vmcnt(15)
    s_cbranch_scc1 L_pw75
    s_waitcnt vmcnt(4)
L_pw75:
    buffer_load_dwordx4 v[104:107], v20, s[4:7], s76 offen nt
    v_add_u32 v20, s9, v20
    s_waitcnt vmcnt(15)
    s_cbranch_scc1 L_pw76
    s_waitcnt vmcnt(4)
L_pw76:
    buffer_load_dwordx4 v[108:111], v20, s[4:7], s76 offen nt
    v_add_u32 v20, s11, v20
    s_waitcnt vmcnt(15)
    s_cbranch_scc1 L_pw77
    s_waitcnt vmcnt(4)
L_pw77:
    buffer_load_dwordx4 v[112:115], v20, s[4:7], s76 offen nt
    v_add_u32 v20, s9, v20
    s_waitcnt vmcnt(15)
    s_cbranch_scc1 L_pw78
    s_waitcnt vmcnt(4)
L_pw78:
    buffer_load_dwordx4 v[116:119], v20, s[4:7], s76 offen nt
    v_add_u32 v20, s10, v20
    s_waitcnt vmcnt(15)
    s_cbranch_scc1 L_pw79
    s_waitcnt vmcnt(4)
L_pw79:
    buffer_load_dwordx4 v[120:123], v20, s[4:7], s76 offen nt
    v_add_u32 v20, s9, v20
    s_waitcnt vmcnt(15)
    s_cbranch_scc1 L_pw80
    s_waitcnt vmcnt(4)
L_pw80:
    buffer_load_dwordx4 v[124:127], v20, s[4:7], s76 offen nt
    v_add_u32 v20, s12, v20
    v_and_b32 v20, 0xfffff, v20
L_vs15:
    s_cmp_eq_u32 s8, 8
    s_cbranch_scc1 L_vdone
    v_mov_b32 v48, v49
    v_mov_b32 v49, v50
    v_mov_b32 v50, v51
    v_mov_b32 v51, v52
    v_mov_b32 v52, v53
    v_mov_b32 v53, v54
    v_mov_b32 v54, v55
    s_cmp_ge_u32 s8, 3
    s_cselect_b32 s80, 0, -1
    v_mov_b32 v32, s80
    ds_write_b32 v33, v32 offset:7200
    s_cmp_ge_u32 s8, 5
    s_cselect_b64 vcc, -1, 0
    s_add_u32 s8, s8, 1
    ds_read_b32 v35, v33 offset:7212
    s_waitcnt lgkmcnt(0)
    v_readfirstlane_b32 s81, v35
    s_nop 1
    s_min_u32 s81, s81, 4
    s_cmp_gt_u32 s8, s81
    v_and_b32_dpp v16, v48, v2 row_newbcast:1 row_mask:0xf bank_mask:0xf
    v_and_b32_dpp v17, v48, v3 row_newbcast:1 row_mask:0xf bank_mask:0xf
    v_and_b32_dpp v18, v48, v4 row_newbcast:1 row_mask:0xf bank_mask:0xf
    v_and_b32_dpp v19, v48, v5 row_newbcast:1 row_mask:0xf bank_mask:0xf
    v_mfma_f32_16x16x32_bf16 v[8:11], v[128:131], v[12:15], v[8:11]
    v_and_b32_dpp v12, v48, v2 row_newbcast:2 row_mask:0xf bank_mask:0xf
    v_and_b32_dpp v13, v48, v3 row_newbcast:2 row_mask:0xf bank_mask:0xf
    v_and_b32_dpp v14, v48, v4 row_newbcast:2 row_mask:0xf bank_mask:0xf
    v_and_b32_dpp v15, v48, v5 row_newbcast:2 row_mask:0xf bank_mask:0xf
    v_mfma_f32_16x16x32_bf16 v[8:11], v[132:135], v[16:19], v[8:11]
    v_and_b32_dpp v16, v48, v2 row_newbcast:3 row_mask:0xf bank_mask:0xf
    v_and_b32_dpp v17, v48, v3 row_newbcast:3 row_mask:0xf bank_mask:0xf
    v_and_b32_dpp v18, v48, v4 row_newbcast:3 row_mask:0xf bank_mask:0xf
    v_and_b32_dpp v19, v48, v5 row_newbcast:3 row_mask:0xf bank_mask:0xf
    v_mfma_f32_16x16x32_bf16 v[8:11], v[136:139], v[12:15], v[8:11]
    v_and_b32_dpp v12, v48, v2 row_newbcast:4 row_mask:0xf bank_mask:0xf
    v_and_b32_dpp v13, v48, v3 row_newbcast:4 row_mask:0xf bank_mask:0xf
    v_and_b32_dpp v14, v48, v4 row_newbcast:4 row_mask:0xf bank_mask:0xf
    v_and_b32_dpp v15, v48, v5 row_newbcast:4 row_mask:0xf bank_mask:0xf
    v_mfma_f32_16x16x32_bf16 v[8:11], v[140:143], v[16:19], v[8:11]
    v_and_b32_dpp v16, v48, v2 row_newbcast:5 row_mask:0xf bank_mask:0xf
    v_and_b32_dpp v17, v48, v3 row_newbcast:5 row_mask:0xf bank_mask:0xf
    v_and_b32_dpp v18, v48, v4 row_newbcast:5 row_mask:0xf bank_mask:0xf
    v_and_b32_dpp v19, v48, v5 row_newbcast:5 row_mask:0xf bank_mask:0xf
    v_mfma_f32_16x16x32_bf16 v[8:11], v[144:147], v[12:15], v[8:11]
    v_and_b32_dpp v12, v48, v2 row_newbcast:6 row_mask:0xf bank_mask:0xf
    v_and_b32_dpp v13, v48, v3 row_newbcast:6 row_mask:0xf bank_mask:0xf
    v_and_b32_dpp v14, v48, v4 row_newbcast:6 row_mask:0xf bank_mask:0xf
    v_and_b32_dpp v15, v48, v5 row_newbcast:6 row_mask:0xf bank_mask:0xf
    v_mfma_f32_16x16x32_bf16 v[8:11], v[148:151], v[16:19], v[8:11]
    v_and_b32_dpp v16, v48, v2 row_newbcast:7 row_mask:0xf bank_mask:0xf
    v_and_b32_dpp v17, v48, v3 row_newbcast:7 row_mask:0xf bank_mask:0xf
    v_and_b32_dpp v18, v48, v4 row_newbcast:7 row_mask:0xf bank_mask:0xf
    v_and_b32_dpp v19, v48, v5 row_newbcast:7 row_mask:0xf bank_mask:0xf
    v_mfma_f32_16x16x32_bf16 v[8:11], v[152:155], v[12:15], v[8:11]
    v_and_b32_dpp v12, v48, v2 row_newbcast:8 row_mask:0xf bank_mask:0xf
    v_and_b32_dpp v13, v48, v3 row_newbcast:8 row_mask:0xf bank_mask:0xf
    v_and_b32_dpp v14, v48, v4 row_newbcast:8 row_mask:0xf bank_mask:0xf
    v_and_b32_dpp v15, v48, v5 row_newbcast:8 row_mask:0xf bank_mask:0xf
    v_mfma_f32_16x16x32_bf16 v[8:11], v[156:159], v[16:19], v[8:11]
    s_cbranch_vccnz L_vs23
    s_waitcnt vmcnt(15)
    s_cbranch_scc1 L_pw81
    s_waitcnt vmcnt(4)
L_pw81:
    buffer_load_dwordx4 v[128:131], v20, s[4:7], s76 offen nt
    v_add_u32 v20, s9, v20
    s_waitcnt vmcnt(15)
    s_cbranch_scc1 L_pw82
    s_waitcnt vmcnt(4)
L_pw82:
    buffer_load_dwordx4 v[132:135], v20, s[4:7], s76 offen nt
    v_add_u32 v20, s10, v20
    s_waitcnt vmcnt(15)
    s_cbranch_scc1 L_pw83
    s_waitcnt vmcnt(4)
L_pw83:
    buffer_load_dwordx4 v[136:139], v20, s[4:7], s76 offen nt
    v_add_u32 v20, s9, v20
    s_waitcnt vmcnt(15)
    s_cbranch_scc1 L_pw84
    s_waitcnt vmcnt(4)
L_pw84:
    buffer_load_dwordx4 v[140:143], v20, s[4:7], s76 offen nt
    v_add_u32 v20, s11, v20
    s_waitcnt vmcnt(15)
    s_cbranch_scc1 L_pw85
    s_waitcnt vmcnt(4)
L_pw85:
    buffer_load_dwordx4 v[144:147], v20, s[4:7], s76 offen nt
    v_add_u32 v20, s9, v20
    s_waitcnt vmcnt(15)
    s_cbranch_scc1 L_pw86
    s_waitcnt vmcnt(4)
L_pw86:
    buffer_load_dwordx4 v[148:151], v20, s[4:7], s76 offen nt
    v_add_u32 v20, s10, v20
    s_waitcnt vmcnt(15)
    s_cbranch_scc1 L_pw87
    s_waitcnt vmcnt(4)
L_pw87:
    buffer_load_dwordx4 v[152:155], v20, s[4:7], s76 offen nt
    v_add_u32 v20, s9, v20
    s_waitcnt vmcnt(15)
    s_cbranch_scc1 L_pw88
    s_waitcnt vmcnt(4)
L_pw88:
    buffer_load_dwordx4 v[156:159], v20, s[4:7], s76 offen nt
    v_add_u32 v20, s12, v20
    v_and_b32 v20, 0xfffff, v20
L_vs23:
    v_and_b32_dpp v16, v48, v2 row_newbcast:9 row_mask:0xf bank_mask:0xf
    v_and_b32_dpp v17, v48, v3 row_newbcast:9 row_mask:0xf bank_mask:0xf
    v_and_b32_dpp v18, v48, v4 row_newbcast:9 row_mask:0xf bank_mask:0xf
    v_and_b32_dpp v19, v48, v5 row_newbcast:9 row_mask:0xf bank_mask:0xf
    v_mfma_f32_16x16x32_bf16 v[8:11], v[160:163], v[12:15], v[8:11]
    v_and_b32_dpp v12, v48, v2 row_newbcast:10 row_mask:0xf bank_mask:0xf
    v_and_b32_dpp v13, v48, v3 row_newbcast:10 row_mask:0xf bank_mask:0xf
    v_and_b32_dpp v14, v48, v4 row_newbcast:10 row_mask:0xf bank_mask:0xf
    v_and_b32_dpp v15, v48, v5 row_newbcast:10 row_mask:0xf bank_mask:0xf
    v_mfma_f32_16x16x32_bf16 v[8:11], v[164:167], v[16:19], v[8:11]
    v_and_b32_dpp v16, v48, v2 row_newbcast:11 row_mask:0xf bank_mask:0xf
    v_and_b32_dpp v17, v48, v3 row_newbcast:11 row_mask:0xf bank_mask:0xf
    v_and_b32_dpp v18, v48, v4 row_newbcast:11 row_mask:0xf bank_mask:0xf
    v_and_b32_dpp v19, v48, v5 row_newbcast:11 row_mask:0xf bank_mask:0xf
    v_mfma_f32_16x16x32_bf16 v[8:11], v[168:171], v[12:15], v[8:11]
    v_and_b32_dpp v12, v48, v2 row_newbcast:12 row_mask:0xf bank_mask:0xf
    v_and_b32_dpp v13, v48, v3 row_newbcast:12 row_mask:0xf bank_mask:0xf
    v_and_b32_dpp v14, v48, v4 row_newbcast:12 row_mask:0xf bank_mask:0xf
    v_and_b32_dpp v15, v48, v5 row_newbcast:12 row_mask:0xf bank_mask:0xf
    v_mfma_f32_16x16x32_bf16 v[8:11], v[172:175], v[16:19], v[8:11]
    v_and_b32_dpp v16, v48, v2 row_newbcast:13 row_mask:0xf bank_mask:0xf
    v_and_b32_dpp v17, v48, v3 row_newbcast:13 row_mask:0xf bank_mask:0xf
    v_and_b32_dpp v18, v48, v4 row_newbcast:13 row_mask:0xf bank_mask:0xf
    v_and_b32_dpp v19, v48, v5 row_newbcast:13 row_mask:0xf bank_mask:0xf
    v_mfma_f32_16x16x32_bf16 v[8:11], v[176:179], v[12:15], v[8:11]
    v_and_b32_dpp v12, v48, v2 row_newbcast:14 row_mask:0xf bank_mask:0xf
    v_and_b32_dpp v13, v48, v3 row_newbcast:14 row_mask:0xf bank_mask:0xf
    v_and_b32_dpp v14, v48, v4 row_newbcast:14 row_mask:0xf bank_mask:0xf
    v_and_b32_dpp v15, v48, v5 row_newbcast:14 row_mask:0xf bank_mask:0xf
    v_mfma_f32_16x16x32_bf16 v[8:11], v[180:183], v[16:19], v[8:11]
    v_and_b32_dpp v16, v48, v2 row_newbcast:15 row_mask:0xf bank_mask:0xf
    v_and_b32_dpp v17, v48, v3 row_newbcast:15 row_mask:0xf bank_mask:0xf
    v_and_b32_dpp v18, v48, v4 row_newbcast:15 row_mask:0xf bank_mask:0xf
    v_and_b32_dpp v19, v48, v5 row_newbcast:15 row_mask:0xf bank_mask:0xf
    v_mfma_f32_16x16x32_bf16 v[8:11], v[184:187], v[12:15], v[8:11]
    v_and_b32_dpp v12, v49, v2 row_newbcast:0 row_mask:0xf bank_mask:0xf
    v_and_b32_dpp v13, v49, v3 row_newbcast:0 row_mask:0xf bank_mask:0xf
    v_and_b32_dpp v14, v49, v4 row_newbcast:0 row_mask:0xf bank_mask:0xf
    v_and_b32_dpp v15, v49, v5 row_newbcast:0 row_mask:0xf bank_mask:0xf
    v_mfma_f32_16x16x32_bf16 v[8:11], v[188:191], v[16:19], v[8:11]
    s_cbranch_vccnz L_vs31
    s_waitcnt vmcnt(15)
    s_cbranch_scc1 L_pw89
    s_waitcnt vmcnt(4)
L_pw89:
    buffer_load_dwordx4 v[160:163], v20, s[4:7], s76 offen nt
    v_add_u32 v20, s9, v20
    s_waitcnt vmcnt(15)
    s_cbranch_scc1 L_pw90
    s_waitcnt vmcnt(4)
L_pw90:
    buffer_load_dwordx4 v[164:167], v20, s[4:7], s76 offen nt
    v_add_u32 v20, s10, v20
    s_waitcnt vmcnt(15)
    s_cbranch_scc1 L_pw91
    s_waitcnt vmcnt(4)
L_pw91:
    buffer_load_dwordx4 v[168:171], v20, s[4:7], s76 offen nt
    v_add_u32 v20, s9, v20
    s_waitcnt vmcnt(15)
    s_cbranch_scc1 L_pw92
    s_waitcnt vmcnt(4)
L_pw92:
    buffer_load_dwordx4 v[172:175], v20, s[4:7], s76 offen nt
    v_add_u32 v20, s11, v20
    s_waitcnt vmcnt(15)
    s_cbranch_scc1 L_pw93
    s_waitcnt vmcnt(4)
L_pw93:
    buffer_load_dwordx4 v[176:179], v20, s[4:7], s76 offen nt
    v_add_u32 v20, s9, v20
    s_waitcnt vmcnt(15)
    s_cbranch_scc1 L_pw94
    s_waitcnt vmcnt(4)
L_pw94:
    buffer_load_dwordx4 v[180:183], v20, s[4:7], s76 offen nt
    v_add_u32 v20, s10, v20
    s_waitcnt vmcnt(15)
    s_cbranch_scc1 L_pw95
    s_waitcnt vmcnt(4)
L_pw95:
    buffer_load_dwordx4 v[184:187], v20, s[4:7], s76 offen nt
    v_add_u32 v20, s9, v20
    s_waitcnt vmcnt(15)
    s_cbranch_scc1 L_pw96
    s_waitcnt vmcnt(4)
L_pw96:
    buffer_load_dwordx4 v[188:191], v20, s[4:7], s76 offen nt
    v_add_u32 v20, s12, v20
    v_and_b32 v20, 0xfffff, v20
L_vs31:
    v_mov_b32 v48, v49
    v_mov_b32 v49, v50
    v_mov_b32 v50, v51
    v_mov_b32 v51, v52
    v_mov_b32 v52, v53
    v_mov_b32 v53, v54
    v_mov_b32 v54, v55
L_ventry:
    s_cmp_ge_u32 s8, 3
    s_cselect_b32 s80, 0, -1
    v_mov_b32 v32, s80
    ds_write_b32 v33, v32 offset:7200
    s_cmp_ge_u32 s8, 5
    s_cselect_b64 vcc, -1, 0
    s_add_u32 s8, s8, 1
    ds_read_b32 v35, v33 offset:7212
    s_waitcnt lgkmcnt(0)
    v_readfirstlane_b32 s81, v35
    s_nop 1
    s_min_u32 s81, s81, 4
    s_cmp_gt_u32 s8, s81
    v_and_b32_dpp v16, v48, v2 row_newbcast:1 row_mask:0xf bank_mask:0xf
    v_and_b32_dpp v17, v48, v3 row_newbcast:1 row_mask:0xf bank_mask:0xf
    v_and_b32_dpp v18, v48, v4 row_newbcast:1 row_mask:0xf bank_mask:0xf
    v_and_b32_dpp v19, v48, v5 row_newbcast:1 row_mask:0xf bank_mask:0xf
    v_mfma_f32_16x16x32_bf16 v[8:11], v[192:195], v[12:15], v[8:11]
    v_and_b32_dpp v12, v48, v2 row_newbcast:2 row_mask:0xf bank_mask:0xf
    v_and_b32_dpp v13, v48, v3 row_newbcast:2 row_mask:0xf bank_mask:0xf
    v_and_b32_dpp v14, v48, v4 row_newbcast:2 row_mask:0xf bank_mask:0xf
    v_and_b32_dpp v15, v48, v5 row_newbcast:2 row_mask:0xf bank_mask:0xf
    v_mfma_f32_16x16x32_bf16 v[8:11], v[196:199], v[16:19], v[8:11]
    v_and_b32_dpp v16, v48, v2 row_newbcast:3 row_mask:0xf bank_mask:0xf
    v_and_b32_dpp v17, v48, v3 row_newbcast:3 row_mask:0xf bank_mask:0xf
    v_and_b32_dpp v18, v48, v4 row_newbcast:3 row_mask:0xf bank_mask:0xf
    v_and_b32_dpp v19, v48, v5 row_newbcast:3 row_mask:0xf bank_mask:0xf
    v_mfma_f32_16x16x32_bf16 v[8:11], v[200:203], v[12:15], v[8:11]
    v_and_b32_dpp v12, v48, v2 row_newbcast:4 row_mask:0xf bank_mask:0xf
    v_and_b32_dpp v13, v48, v3 row_newbcast:4 row_mask:0xf bank_mask:0xf
    v_and_b32_dpp v14, v48, v4 row_newbcast:4 row_mask:0xf bank_mask:0xf
    v_and_b32_dpp v15, v48, v5 row_newbcast:4 row_mask:0xf bank_mask:0xf
    v_mfma_f32_16x16x32_bf16 v[8:11], v[204:207], v[16:19], v[8:11]
    v_and_b32_dpp v16, v48, v2 row_newbcast:5 row_mask:0xf bank_mask:0xf
    v_and_b32_dpp v17, v48, v3 row_newbcast:5 row_mask:0xf bank_mask:0xf
    v_and_b32_dpp v18, v48, v4 row_newbcast:5 row_mask:0xf bank_mask:0xf
    v_and_b32_dpp v19, v48, v5 row_newbcast:5 row_mask:0xf bank_mask:0xf
    v_mfma_f32_16x16x32_bf16 v[8:11], v[208:211], v[12:15], v[8:11]
    v_and_b32_dpp v12, v48, v2 row_newbcast:6 row_mask:0xf bank_mask:0xf
    v_and_b32_dpp v13, v48, v3 row_newbcast:6 row_mask:0xf bank_mask:0xf
    v_and_b32_dpp v14, v48, v4 row_newbcast:6 row_mask:0xf bank_mask:0xf
    v_and_b32_dpp v15, v48, v5 row_newbcast:6 row_mask:0xf bank_mask:0xf
    v_mfma_f32_16x16x32_bf16 v[8:11], v[212:215], v[16:19], v[8:11]
    v_and_b32_dpp v16, v48, v2 row_newbcast:7 row_mask:0xf bank_mask:0xf
    v_and_b32_dpp v17, v48, v3 row_newbcast:7 row_mask:0xf bank_mask:0xf
    v_and_b32_dpp v18, v48, v4 row_newbcast:7 row_mask:0xf bank_mask:0xf
    v_and_b32_dpp v19, v48, v5 row_newbcast:7 row_mask:0xf bank_mask:0xf
    v_mfma_f32_16x16x32_bf16 v[8:11], v[216:219], v[12:15], v[8:11]
    v_and_b32_dpp v12, v48, v2 row_newbcast:8 row_mask:0xf bank_mask:0xf
    v_and_b32_dpp v13, v48, v3 row_newbcast:8 row_mask:0xf bank_mask:0xf
    v_and_b32_dpp v14, v48, v4 row_newbcast:8 row_mask:0xf bank_mask:0xf
    v_and_b32_dpp v15, v48, v5 row_newbcast:8 row_mask:0xf bank_mask:0xf
    v_mfma_f32_16x16x32_bf16 v[8:11], v[220:223], v[16:19], v[8:11]
    s_cbranch_vccnz L_vs39
    s_waitcnt vmcnt(15)
    s_cbranch_scc1 L_pw97
    s_waitcnt vmcnt(4)
L_pw97:
    buffer_load_dwordx4 v[192:195], v20, s[4:7], s76 offen nt
    v_add_u32 v20, s9, v20
    s_waitcnt vmcnt(15)
    s_cbranch_scc1 L_pw98
    s_waitcnt vmcnt(4)
L_pw98:
    buffer_load_dwordx4 v[196:199], v20, s[4:7], s76 offen nt
    v_add_u32 v20, s10, v20
    s_waitcnt vmcnt(15)
    s_cbranch_scc1 L_pw99
    s_waitcnt vmcnt(4)
L_pw99:
    buffer_load_dwordx4 v[200:203], v20, s[4:7], s76 offen nt
    v_add_u32 v20, s9, v20
    s_waitcnt vmcnt(15)
    s_cbranch_scc1 L_pw100
    s_waitcnt vmcnt(4)
L_pw100:
    buffer_load_dwordx4 v[204:207], v20, s[4:7], s76 offen nt
    v_add_u32 v20, s11, v20
    s_waitcnt vmcnt(15)
    s_cbranch_scc1 L_pw101
    s_waitcnt vmcnt(4)
L_pw101:
    buffer_load_dwordx4 v[208:211], v20, s[4:7], s76 offen nt
    v_add_u32 v20, s9, v20
    s_waitcnt vmcnt(15)
    s_cbranch_scc1 L_pw102
    s_waitcnt vmcnt(4)
L_pw102:
    buffer_load_dwordx4 v[212:215], v20, s[4:7], s76 offen nt
    v_add_u32 v20, s10, v20
    s_waitcnt vmcnt(15)
    s_cbranch_scc1 L_pw103
    s_waitcnt vmcnt(4)
L_pw103:
    buffer_load_dwordx4 v[216:219], v20, s[4:7], s76 offen nt
    v_add_u32 v20, s9, v20
    s_waitcnt vmcnt(15)
    s_cbranch_scc1 L_pw104
    s_waitcnt vmcnt(4)
L_pw104:
    buffer_load_dwordx4 v[220:223], v20, s[4:7], s76 offen nt
    v_add_u32 v20, s12, v20
    v_and_b32 v20, 0xfffff, v20
L_vs39:
    v_and_b32_dpp v16, v48, v2 row_newbcast:9 row_mask:0xf bank_mask:0xf
    v_and_b32_dpp v17, v48, v3 row_newbcast:9 row_mask:0xf bank_mask:0xf
    v_and_b32_dpp v18, v48, v4 row_newbcast:9 row_mask:0xf bank_mask:0xf
    v_and_b32_dpp v19, v48, v5 row_newbcast:9 row_mask:0xf bank_mask:0xf
    v_mfma_f32_16x16x32_bf16 v[8:11], v[224:227], v[12:15], v[8:11]
    v_and_b32_dpp v12, v48, v2 row_newbcast:10 row_mask:0xf bank_mask:0xf
    v_and_b32_dpp v13, v48, v3 row_newbcast:10 row_mask:0xf bank_mask:0xf
    v_and_b32_dpp v14, v48, v4 row_newbcast:10 row_mask:0xf bank_mask:0xf
    v_and_b32_dpp v15, v48, v5 row_newbcast:10 row_mask:0xf bank_mask:0xf
    v_mfma_f32_16x16x32_bf16 v[8:11], v[228:231], v[16:19], v[8:11]
    v_and_b32_dpp v16, v48, v2 row_newbcast:11 row_mask:0xf bank_mask:0xf
    v_and_b32_dpp v17, v48, v3 row_newbcast:11 row_mask:0xf bank_mask:0xf
    v_and_b32_dpp v18, v48, v4 row_newbcast:11 row_mask:0xf bank_mask:0xf
    v_and_b32_dpp v19, v48, v5 row_newbcast:11 row_mask:0xf bank_mask:0xf
    v_mfma_f32_16x16x32_bf16 v[8:11], v[232:235], v[12:15], v[8:11]
    v_and_b32_dpp v12, v48, v2 row_newbcast:12 row_mask:0xf bank_mask:0xf
    v_and_b32_dpp v13, v48, v3 row_newbcast:12 row_mask:0xf bank_mask:0xf
    v_and_b32_dpp v14, v48, v4 row_newbcast:12 row_mask:0xf bank_mask:0xf
    v_and_b32_dpp v15, v48, v5 row_newbcast:12 row_mask:0xf bank_mask:0xf
    v_mfma_f32_16x16x32_bf16 v[8:11], v[236:239], v[16:19], v[8:11]
    v_and_b32_dpp v16, v48, v2 row_newbcast:13 row_mask:0xf bank_mask:0xf
    v_and_b32_dpp v17, v48, v3 row_newbcast:13 row_mask:0xf bank_mask:0xf
    v_and_b32_dpp v18, v48, v4 row_newbcast:13 row_mask:0xf bank_mask:0xf
    v_and_b32_dpp v19, v48, v5 row_newbcast:13 row_mask:0xf bank_mask:0xf
    v_mfma_f32_16x16x32_bf16 v[8:11], v[240:243], v[12:15], v[8:11]
    v_and_b32_dpp v12, v48, v2 row_newbcast:14 row_mask:0xf bank_mask:0xf
    v_and_b32_dpp v13, v48, v3 row_newbcast:14 row_mask:0xf bank_mask:0xf
    v_and_b32_dpp v14, v48, v4 row_newbcast:14 row_mask:0xf bank_mask:0xf
    v_and_b32_dpp v15, v48, v5 row_newbcast:14 row_mask:0xf bank_mask:0xf
    v_mfma_f32_16x16x32_bf16 v[8:11], v[244:247], v[16:19], v[8:11]
    v_and_b32_dpp v16, v48, v2 row_newbcast:15 row_mask:0xf bank_mask:0xf
    v_and_b32_dpp v17, v48, v3 row_newbcast:15 row_mask:0xf bank_mask:0xf
    v_and_b32_dpp v18, v48, v4 row_newbcast:15 row_mask:0xf bank_mask:0xf
    v_and_b32_dpp v19, v48, v5 row_newbcast:15 row_mask:0xf bank_mask:0xf
    v_mfma_f32_16x16x32_bf16 v[8:11], v[248:251], v[12:15], v[8:11]
    v_and_b32_dpp v12, v49, v2 row_newbcast:0 row_mask:0xf bank_mask:0xf
    v_and_b32_dpp v13, v49, v3 row_newbcast:0 row_mask:0xf bank_mask:0xf
    v_and_b32_dpp v14, v49, v4 row_newbcast:0 row_mask:0xf bank_mask:0xf
    v_and_b32_dpp v15, v49, v5 row_newbcast:0 row_mask:0xf bank_mask:0xf
    v_mfma_f32_16x16x32_bf16 v[8:11], v[252:255], v[16:19], v[8:11]
    s_cbranch_vccnz L_vs47
    s_waitcnt vmcnt(15)
    s_cbranch_scc1 L_pw105
    s_waitcnt vmcnt(4)
L_pw105:
    buffer_load_dwordx4 v[224:227], v20, s[4:7], s76 offen nt
    v_add_u32 v20, s9, v20
    s_waitcnt vmcnt(15)
    s_cbranch_scc1 L_pw106
    s_waitcnt vmcnt(4)
L_pw106:
    buffer_load_dwordx4 v[228:231], v20, s[4:7], s76 offen nt
    v_add_u32 v20, s10, v20
    s_waitcnt vmcnt(15)
    s_cbranch_scc1 L_pw107
    s_waitcnt vmcnt(4)
L_pw107:
    buffer_load_dwordx4 v[232:235], v20, s[4:7], s76 offen nt
    v_add_u32 v20, s9, v20
    s_waitcnt vmcnt(15)
    s_cbranch_scc1 L_pw108
    s_waitcnt vmcnt(4)
L_pw108:
    buffer_load_dwordx4 v[236:239], v20, s[4:7], s76 offen nt
    v_add_u32 v20, s11, v20
    s_waitcnt vmcnt(15)
    s_cbranch_scc1 L_pw109
    s_waitcnt vmcnt(4)
L_pw109:
    buffer_load_dwordx4 v[240:243], v20, s[4:7], s76 offen nt
    v_add_u32 v20, s9, v20
    s_waitcnt vmcnt(15)
    s_cbranch_scc1 L_pw110
    s_waitcnt vmcnt(4)
L_pw110:
    buffer_load_dwordx4 v[244:247], v20, s[4:7], s76 offen nt
    v_add_u32 v20, s10, v20
    s_waitcnt vmcnt(15)
    s_cbranch_scc1 L_pw111
    s_waitcnt vmcnt(4)
L_pw111:
    buffer_load_dwordx4 v[248:251], v20, s[4:7], s76 offen nt
    v_add_u32 v20, s9, v20
    s_waitcnt vmcnt(15)
    s_cbranch_scc1 L_pw112
    s_waitcnt vmcnt(4)
L_pw112:
    buffer_load_dwordx4 v[252:255], v20, s[4:7], s76 offen nt
    v_add_u32 v20, s12, v20
    v_and_b32 v20, 0xfffff, v20
L_vs47:
    v_mov_b32 v48, v49
    v_mov_b32 v49, v50
    v_mov_b32 v50, v51
    v_mov_b32 v51, v52
    v_mov_b32 v52, v53
    v_mov_b32 v53, v54
    v_mov_b32 v54, v55
    s_branch L_vloop
L_vdone:
    s_nop 5
    v_cvt_pk_bf16_f32 v32, v8, v9
    v_cvt_pk_bf16_f32 v33, v10, v11
    ds_write_b64 v6, v[32:33] offset:2048
    s_waitcnt lgkmcnt(0)
    s_barrier
    s_endpgm
L_helper:
    s_and_b32 s72, s72, 3
    v_mov_b32 v168, -1
    v_mov_b32 v169, -1
    v_mov_b32 v170, -1
    v_mov_b32 v171, -1
    v_mov_b32 v1, 0
    ds_write_b128 v1, v[168:171] offset:7168
    ds_write_b128 v1, v[168:171] offset:7184
    ds_write_b128 v1, v[168:171] offset:7200
    ds_write_b128 v1, v[168:171] offset:7216
    ds_write_b128 v1, v[168:171] offset:7232
    v_lshrrev_b32 v160, 4, v0
    v_and_b32 v161, 15, v0
    s_and_b32 s93, s81, 7
    s_lshl_b32 s93, s93, 2
    v_lshlrev_b32 v28, 13, v160
    v_lshl_add_u32 v28, v161, 4, v28
    s_lshl_b32 s77, s72, 20
    s_lshl_b32 s83, s73, 8
    s_add_u32 s77, s77, s83
    s_lshl_b32 s97, s93, 15
    s_lshl_b32 s96, s74, 10
    s_lshl_b32 s83, s72, 8
    s_add_u32 s83, s83, s96
    v_add_u32 v200, s93, v161
    v_and_b32 v200, 31, v200
    v_lshl_add_u32 v200, v200, 2, v160
    v_lshl_add_u32 v164, v200, 1, s83
    v_add_u32 v200, s93, v161
    v_add_u32 v200, 16, v200
    v_and_b32 v200, 31, v200
    v_lshl_add_u32 v200, v200, 2, v160
    v_lshl_add_u32 v165, v200, 1, s83
    v_lshlrev_b32 v166, 4, v0
    v_add_u32 v166, s96, v166
    s_mov_b32 s26, 2048
    s_mov_b32 s27, 0x20000
    s_mov_b32 s14, 0x400000
    s_mov_b32 s15, 0x20000
    s_waitcnt lgkmcnt(0)
    s_mov_b32 s24, s48
    s_mov_b32 s25, s49
    s_mov_b32 s12, s54
    s_mov_b32 s13, s55
    buffer_load_dwordx4 v[172:175], v166, s[24:27], 0 offen
    buffer_load_ushort v20, v164, s[24:27], 0 offen
    buffer_load_ushort v21, v165, s[24:27], 0 offen
    s_barrier
    s_getpc_b64 s[4:5]
L_pc:
    s_sub_u32 s4, s4, L_pc-sequential_preLN__mha_block_cached__geglu_ffn__decode_kernel
    s_subb_u32 s5, s5, 0
    s_lshl_b32 s83, s81, 2
    s_add_u32 s83, s83, s72
    s_lshl_b32 s83, s83, 8
    v_lshl_add_u32 v167, v0, 7, s83
    v_min_u32 v167, L_end-sequential_preLN__mha_block_cached__geglu_ffn__decode_kernel, v167
    s_mov_b64 exec, 3
    global_load_dword v162, v167, s[4:5]
    s_mov_b64 exec, -1
    s_add_u32 s83, s77, s97
    buffer_load_dwordx4 v[32:35], v28, s[12:15], s83 offen
    s_add_u32 s97, s97, 0x8000
    s_and_b32 s97, s97, 0xfffff
    s_add_u32 s83, s77, s97
    buffer_load_dwordx4 v[36:39], v28, s[12:15], s83 offen
    s_add_u32 s97, s97, 0x8000
    s_and_b32 s97, s97, 0xfffff
    s_add_u32 s83, s77, s97
    buffer_load_dwordx4 v[40:43], v28, s[12:15], s83 offen
    s_add_u32 s97, s97, 0x8000
    s_and_b32 s97, s97, 0xfffff
    s_add_u32 s83, s77, s97
    buffer_load_dwordx4 v[44:47], v28, s[12:15], s83 offen
    s_add_u32 s97, s97, 0x8000
    s_and_b32 s97, s97, 0xfffff
    s_sub_u32 s79, s2, 64
    s_cmp_eq_u32 s72, 0
    s_cselect_b32 s79, s79, 64
    s_min_u32 s79, s79, 64
    s_mov_b32 s20, s70
    s_mov_b32 s21, s71
    s_mov_b32 s22, 1048576
    s_mov_b32 s23, 0x20000
    s_mov_b32 s95, 16
    s_lshr_b32 s3, s79, 3
    s_lshl_b32 s3, s3, 2
    s_and_b32 s83, s79, 3
    s_add_u32 s3, s3, s83
    s_lshl_b32 s3, s3, 15
    s_and_b32 s83, s79, 4
    s_lshl_b32 s86, s83, 7
    s_lshl_b32 s83, s83, 11
    s_add_u32 s3, s3, s83
    s_add_u32 s86, s86, s3
    s_add_u32 s86, s86, 0x4c00
    s_xor_b32 s87, s86, 0x2000
    v_and_b32 v1, 1, v0
    v_lshlrev_b32 v1, 4, v1
    v_mov_b32 v7, 0xffff
    v_lshlrev_b32 v7, v1, v7
    v_bfe_u32 v1, v0, 1, 2
    v_cmp_eq_u32 vcc, 0, v1
    s_nop 1
    v_cndmask_b32 v2, 0, v7, vcc
    v_cmp_eq_u32 vcc, 1, v1
    s_nop 1
    v_cndmask_b32 v3, 0, v7, vcc
    v_cmp_eq_u32 vcc, 2, v1
    s_nop 1
    v_cndmask_b32 v4, 0, v7, vcc
    v_cmp_eq_u32 vcc, 3, v1
    s_nop 1
    v_cndmask_b32 v5, 0, v7, vcc
    v_lshlrev_b32 v6, 9, v160
    v_and_b32 v1, 7, v0
    v_lshl_add_u32 v6, v1, 4, v6
    s_lshl_b32 s83, s72, 2
    v_add_u32 v6, s83, v6
    s_waitcnt vmcnt(7)
    v_lshlrev_b32 v176, 16, v172
    v_and_b32 v177, 0xffff0000, v172
    v_lshlrev_b32 v178, 16, v173
    v_and_b32 v179, 0xffff0000, v173
    v_lshlrev_b32 v180, 16, v174
    v_and_b32 v181, 0xffff0000, v174
    v_lshlrev_b32 v182, 16, v175
    v_and_b32 v183, 0xffff0000, v175
    v_readfirstlane_b32 s82, v176
    s_nop 1
    s_mov_b32 s83, s82
    v_pk_add_f32 v[184:185], v[176:177], s[82:83] neg_lo:[0,1] neg_hi:[0,1]
    v_pk_add_f32 v[186:187], v[178:179], s[82:83] neg_lo:[0,1] neg_hi:[0,1]
    v_pk_add_f32 v[188:189], v[180:181], s[82:83] neg_lo:[0,1] neg_hi:[0,1]
    v_pk_add_f32 v[190:191], v[182:183], s[82:83] neg_lo:[0,1] neg_hi:[0,1]
    v_pk_add_f32 v[192:193], v[184:185], v[186:187]
    v_pk_mul_f32 v[194:195], v[184:185], v[184:185]
    v_pk_add_f32 v[196:197], v[188:189], v[190:191]
    v_pk_fma_f32 v[194:195], v[186:187], v[186:187], v[194:195]
    v_pk_fma_f32 v[194:195], v[188:189], v[188:189], v[194:195]
    v_pk_fma_f32 v[194:195], v[190:191], v[190:191], v[194:195]
    v_pk_add_f32 v[192:193], v[192:193], v[196:197]
    v_add_f32 v194, v194, v195
    v_add_f32 v192, v192, v193
    s_nop 1
    v_add_f32_dpp v192, v192, v192 row_ror:8 row_mask:0xf bank_mask:0xf
    v_add_f32_dpp v194, v194, v194 row_ror:8 row_mask:0xf bank_mask:0xf
    s_nop 0
    v_add_f32_dpp v192, v192, v192 row_ror:4 row_mask:0xf bank_mask:0xf
    v_add_f32_dpp v194, v194, v194 row_ror:4 row_mask:0xf bank_mask:0xf
    s_nop 0
    v_add_f32_dpp v192, v192, v192 row_ror:2 row_mask:0xf bank_mask:0xf
    v_add_f32_dpp v194, v194, v194 row_ror:2 row_mask:0xf bank_mask:0xf
    s_nop 0
    v_add_f32_dpp v192, v192, v192 row_ror:1 row_mask:0xf bank_mask:0xf
    v_add_f32_dpp v194, v194, v194 row_ror:1 row_mask:0xf bank_mask:0xf
    v_mov_b32 v193, v192
    v_mov_b32 v195, v194
    s_nop 0
    v_permlane16_swap_b32 v192, v193
    v_permlane16_swap_b32 v194, v195
    v_add_f32 v192, v192, v193
    v_add_f32 v194, v194, v195
    v_mov_b32 v193, v192
    v_mov_b32 v195, v194
    s_nop 0
    v_permlane32_swap_b32 v192, v193
    v_permlane32_swap_b32 v194, v195
    v_add_f32 v192, v192, v193
    v_add_f32 v194, v194, v195
    v_mul_f32 v192, 0x3b000000, v192
    v_mul_f32 v194, 0x3b000000, v194
    v_fma_f32 v194, -v192, v192, v194
    v_add_f32 v192, s82, v192
    v_max_f32 v194, 0, v194
    v_cvt_pk_bf16_f32 v192, v192, v192
    v_and_b32 v192, 0xffff0000, v192
    v_cvt_pk_bf16_f32 v194, v194, v194
    v_and_b32 v194, 0xffff0000, v194
    v_add_f32 v194, 0x3727c5ac, v194
    v_cvt_pk_bf16_f32 v194, v194, v194
    v_and_b32 v194, 0xffff0000, v194
    v_sqrt_f32 v194, v194
    s_nop 0
    v_cvt_pk_bf16_f32 v194, v194, v194
    v_and_b32 v194, 0xffff0000, v194
    v_rcp_f32 v194, v194
    s_waitcnt vmcnt(5)
    v_lshlrev_b32 v20, 16, v20
    v_sub_f32 v20, v20, v192
    v_cvt_pk_bf16_f32 v20, v20, v20
    v_and_b32 v20, 0xffff0000, v20
    v_mul_f32 v20, v20, v194
    v_cvt_pk_bf16_f32 v20, v20, v20
    v_lshlrev_b32 v21, 16, v21
    v_sub_f32 v21, v21, v192
    v_cvt_pk_bf16_f32 v21, v21, v21
    v_and_b32 v21, 0xffff0000, v21
    v_mul_f32 v21, v21, v194
    v_cvt_pk_bf16_f32 v21, v21, v21
    v_and_b32_dpp v12, v20, v2 row_newbcast:0 row_mask:0xf bank_mask:0xf
    v_and_b32_dpp v13, v20, v3 row_newbcast:0 row_mask:0xf bank_mask:0xf
    v_and_b32_dpp v14, v20, v4 row_newbcast:0 row_mask:0xf bank_mask:0xf
    v_and_b32_dpp v15, v20, v5 row_newbcast:0 row_mask:0xf bank_mask:0xf
    v_and_b32_dpp v16, v20, v2 row_newbcast:1 row_mask:0xf bank_mask:0xf
    v_and_b32_dpp v17, v20, v3 row_newbcast:1 row_mask:0xf bank_mask:0xf
    v_and_b32_dpp v18, v20, v4 row_newbcast:1 row_mask:0xf bank_mask:0xf
    v_and_b32_dpp v19, v20, v5 row_newbcast:1 row_mask:0xf bank_mask:0xf
    s_waitcnt vmcnt(3)
    s_add_u32 s83, s77, s97
    buffer_load_dwordx4 v[48:51], v28, s[12:15], s83 offen
    s_add_u32 s97, s97, 0x8000
    s_and_b32 s97, s97, 0xfffff
    v_mfma_f32_16x16x32_bf16 v[8:11], v[32:35], v[12:15], 0
    v_and_b32_dpp v12, v20, v2 row_newbcast:2 row_mask:0xf bank_mask:0xf
    v_and_b32_dpp v13, v20, v3 row_newbcast:2 row_mask:0xf bank_mask:0xf
    v_and_b32_dpp v14, v20, v4 row_newbcast:2 row_mask:0xf bank_mask:0xf
    v_and_b32_dpp v15, v20, v5 row_newbcast:2 row_mask:0xf bank_mask:0xf
    s_waitcnt vmcnt(3)
    s_add_u32 s83, s77, s97
    buffer_load_dwordx4 v[52:55], v28, s[12:15], s83 offen
    s_add_u32 s97, s97, 0x8000
    s_and_b32 s97, s97, 0xfffff
    v_mfma_f32_16x16x32_bf16 v[8:11], v[36:39], v[16:19], v[8:11]
    v_and_b32_dpp v16, v20, v2 row_newbcast:3 row_mask:0xf bank_mask:0xf
    v_and_b32_dpp v17, v20, v3 row_newbcast:3 row_mask:0xf bank_mask:0xf
    v_and_b32_dpp v18, v20, v4 row_newbcast:3 row_mask:0xf bank_mask:0xf
    v_and_b32_dpp v19, v20, v5 row_newbcast:3 row_mask:0xf bank_mask:0xf
    s_waitcnt vmcnt(3)
    s_add_u32 s83, s77, s97
    buffer_load_dwordx4 v[56:59], v28, s[12:15], s83 offen
    s_add_u32 s97, s97, 0x8000
    s_and_b32 s97, s97, 0xfffff
    v_mfma_f32_16x16x32_bf16 v[8:11], v[40:43], v[12:15], v[8:11]
    v_and_b32_dpp v12, v20, v2 row_newbcast:4 row_mask:0xf bank_mask:0xf
    v_and_b32_dpp v13, v20, v3 row_newbcast:4 row_mask:0xf bank_mask:0xf
    v_and_b32_dpp v14, v20, v4 row_newbcast:4 row_mask:0xf bank_mask:0xf
    v_and_b32_dpp v15, v20, v5 row_newbcast:4 row_mask:0xf bank_mask:0xf
    s_waitcnt vmcnt(3)
    s_add_u32 s83, s77, s97
    buffer_load_dwordx4 v[60:63], v28, s[12:15], s83 offen
    s_add_u32 s97, s97, 0x8000
    s_and_b32 s97, s97, 0xfffff
    v_mfma_f32_16x16x32_bf16 v[8:11], v[44:47], v[16:19], v[8:11]
    v_and_b32_dpp v16, v20, v2 row_newbcast:5 row_mask:0xf bank_mask:0xf
    v_and_b32_dpp v17, v20, v3 row_newbcast:5 row_mask:0xf bank_mask:0xf
    v_and_b32_dpp v18, v20, v4 row_newbcast:5 row_mask:0xf bank_mask:0xf
    v_and_b32_dpp v19, v20, v5 row_newbcast:5 row_mask:0xf bank_mask:0xf
    s_waitcnt vmcnt(3)
    s_add_u32 s83, s77, s97
    buffer_load_dwordx4 v[64:67], v28, s[12:15], s83 offen
    s_add_u32 s97, s97, 0x8000
    s_and_b32 s97, s97, 0xfffff
    v_mfma_f32_16x16x32_bf16 v[8:11], v[48:51], v[12:15], v[8:11]
    v_and_b32_dpp v12, v20, v2 row_newbcast:6 row_mask:0xf bank_mask:0xf
    v_and_b32_dpp v13, v20, v3 row_newbcast:6 row_mask:0xf bank_mask:0xf
    v_and_b32_dpp v14, v20, v4 row_newbcast:6 row_mask:0xf bank_mask:0xf
    v_and_b32_dpp v15, v20, v5 row_newbcast:6 row_mask:0xf bank_mask:0xf
    s_waitcnt vmcnt(3)
    s_add_u32 s83, s77, s97
    buffer_load_dwordx4 v[68:71], v28, s[12:15], s83 offen
    s_add_u32 s97, s97, 0x8000
    s_and_b32 s97, s97, 0xfffff
    v_mfma_f32_16x16x32_bf16 v[8:11], v[52:55], v[16:19], v[8:11]
    v_and_b32_dpp v16, v20, v2 row_newbcast:7 row_mask:0xf bank_mask:0xf
    v_and_b32_dpp v17, v20, v3 row_newbcast:7 row_mask:0xf bank_mask:0xf
    v_and_b32_dpp v18, v20, v4 row_newbcast:7 row_mask:0xf bank_mask:0xf
    v_and_b32_dpp v19, v20, v5 row_newbcast:7 row_mask:0xf bank_mask:0xf
    s_waitcnt vmcnt(3)
    s_add_u32 s83, s77, s97
    buffer_load_dwordx4 v[72:75], v28, s[12:15], s83 offen
    s_add_u32 s97, s97, 0x8000
    s_and_b32 s97, s97, 0xfffff
    v_mfma_f32_16x16x32_bf16 v[8:11], v[56:59], v[12:15], v[8:11]
    s_cmp_lt_u32 s79, 64
    s_cbranch_scc0 L_nop0
    s_waitcnt lgkmcnt(0)
    s_load_dword s58, s[70:71], s86
    s_load_dword s59, s[70:71], s87
    s_waitcnt lgkmcnt(1)
    s_getreg_b32 s82, hwreg(HW_REG_IB_STS, 8, 4)
    s_cmp_lg_u32 s82, 0
    s_cselect_b32 s82, 1, 0
    s_add_u32 s95, s95, s82
    s_add_u32 s86, s86, 128
    s_add_u32 s87, s87, 128
L_nop0:
    v_and_b32_dpp v12, v20, v2 row_newbcast:8 row_mask:0xf bank_mask:0xf
    v_and_b32_dpp v13, v20, v3 row_newbcast:8 row_mask:0xf bank_mask:0xf
    v_and_b32_dpp v14, v20, v4 row_newbcast:8 row_mask:0xf bank_mask:0xf
    v_and_b32_dpp v15, v20, v5 row_newbcast:8 row_mask:0xf bank_mask:0xf
    s_waitcnt vmcnt(3)
    s_add_u32 s83, s77, s97
    buffer_load_dwordx4 v[76:79], v28, s[12:15], s83 offen
    s_add_u32 s97, s97, 0x8000
    s_and_b32 s97, s97, 0xfffff
    v_mfma_f32_16x16x32_bf16 v[8:11], v[60:63], v[16:19], v[8:11]
    v_and_b32_dpp v16, v20, v2 row_newbcast:9 row_mask:0xf bank_mask:0xf
    v_and_b32_dpp v17, v20, v3 row_newbcast:9 row_mask:0xf bank_mask:0xf
    v_and_b32_dpp v18, v20, v4 row_newbcast:9 row_mask:0xf bank_mask:0xf
    v_and_b32_dpp v19, v20, v5 row_newbcast:9 row_mask:0xf bank_mask:0xf
    s_waitcnt vmcnt(3)
    s_add_u32 s83, s77, s97
    buffer_load_dwordx4 v[80:83], v28, s[12:15], s83 offen
    s_add_u32 s97, s97, 0x8000
    s_and_b32 s97, s97, 0xfffff
    v_mfma_f32_16x16x32_bf16 v[8:11], v[64:67], v[12:15], v[8:11]
    v_and_b32_dpp v12, v20, v2 row_newbcast:10 row_mask:0xf bank_mask:0xf
    v_and_b32_dpp v13, v20, v3 row_newbcast:10 row_mask:0xf bank_mask:0xf
    v_and_b32_dpp v14, v20, v4 row_newbcast:10 row_mask:0xf bank_mask:0xf
    v_and_b32_dpp v15, v20, v5 row_newbcast:10 row_mask:0xf bank_mask:0xf
    s_waitcnt vmcnt(3)
    s_add_u32 s83, s77, s97
    buffer_load_dwordx4 v[84:87], v28, s[12:15], s83 offen
    s_add_u32 s97, s97, 0x8000
    s_and_b32 s97, s97, 0xfffff
    v_mfma_f32_16x16x32_bf16 v[8:11], v[68:71], v[16:19], v[8:11]
    v_and_b32_dpp v16, v20, v2 row_newbcast:11 row_mask:0xf bank_mask:0xf
    v_and_b32_dpp v17, v20, v3 row_newbcast:11 row_mask:0xf bank_mask:0xf
    v_and_b32_dpp v18, v20, v4 row_newbcast:11 row_mask:0xf bank_mask:0xf
    v_and_b32_dpp v19, v20, v5 row_newbcast:11 row_mask:0xf bank_mask:0xf
    s_waitcnt vmcnt(3)
    s_add_u32 s83, s77, s97
    buffer_load_dwordx4 v[88:91], v28, s[12:15], s83 offen
    s_add_u32 s97, s97, 0x8000
    s_and_b32 s97, s97, 0xfffff
    v_mfma_f32_16x16x32_bf16 v[8:11], v[72:75], v[12:15], v[8:11]
    v_and_b32_dpp v12, v20, v2 row_newbcast:12 row_mask:0xf bank_mask:0xf
    v_and_b32_dpp v13, v20, v3 row_newbcast:12 row_mask:0xf bank_mask:0xf
    v_and_b32_dpp v14, v20, v4 row_newbcast:12 row_mask:0xf bank_mask:0xf
    v_and_b32_dpp v15, v20, v5 row_newbcast:12 row_mask:0xf bank_mask:0xf
    s_waitcnt vmcnt(3)
    s_add_u32 s83, s77, s97
    buffer_load_dwordx4 v[92:95], v28, s[12:15], s83 offen
    s_add_u32 s97, s97, 0x8000
    s_and_b32 s97, s97, 0xfffff
    v_mfma_f32_16x16x32_bf16 v[8:11], v[76:79], v[16:19], v[8:11]
    v_and_b32_dpp v16, v20, v2 row_newbcast:13 row_mask:0xf bank_mask:0xf
    v_and_b32_dpp v17, v20, v3 row_newbcast:13 row_mask:0xf bank_mask:0xf
    v_and_b32_dpp v18, v20, v4 row_newbcast:13 row_mask:0xf bank_mask:0xf
    v_and_b32_dpp v19, v20, v5 row_newbcast:13 row_mask:0xf bank_mask:0xf
    s_waitcnt vmcnt(3)
    s_add_u32 s83, s77, s97
    buffer_load_dwordx4 v[96:99], v28, s[12:15], s83 offen
    s_add_u32 s97, s97, 0x8000
    s_and_b32 s97, s97, 0xfffff
    v_mfma_f32_16x16x32_bf16 v[8:11], v[80:83], v[12:15], v[8:11]
    v_and_b32_dpp v12, v20, v2 row_newbcast:14 row_mask:0xf bank_mask:0xf
    v_and_b32_dpp v13, v20, v3 row_newbcast:14 row_mask:0xf bank_mask:0xf
    v_and_b32_dpp v14, v20, v4 row_newbcast:14 row_mask:0xf bank_mask:0xf
    v_and_b32_dpp v15, v20, v5 row_newbcast:14 row_mask:0xf bank_mask:0xf
    s_waitcnt vmcnt(3)
    s_add_u32 s83, s77, s97
    buffer_load_dwordx4 v[100:103], v28, s[12:15], s83 offen
    s_add_u32 s97, s97, 0x8000
    s_and_b32 s97, s97, 0xfffff
    v_mfma_f32_16x16x32_bf16 v[8:11], v[84:87], v[16:19], v[8:11]
    v_and_b32_dpp v16, v20, v2 row_newbcast:15 row_mask:0xf bank_mask:0xf
    v_and_b32_dpp v17, v20, v3 row_newbcast:15 row_mask:0xf bank_mask:0xf
    v_and_b32_dpp v18, v20, v4 row_newbcast:15 row_mask:0xf bank_mask:0xf
    v_and_b32_dpp v19, v20, v5 row_newbcast:15 row_mask:0xf bank_mask:0xf
    s_waitcnt vmcnt(3)
    s_add_u32 s83, s77, s97
    buffer_load_dwordx4 v[104:107], v28, s[12:15], s83 offen
    s_add_u32 s97, s97, 0x8000
    s_and_b32 s97, s97, 0xfffff
    v_mfma_f32_16x16x32_bf16 v[8:11], v[88:91], v[12:15], v[8:11]
    s_cmp_lt_u32 s79, 64
    s_cbranch_scc0 L_nop1
    s_waitcnt lgkmcnt(0)
    s_load_dword s59, s[70:71], s87
    s_load_dword s58, s[70:71], s86
    s_waitcnt lgkmcnt(1)
    s_getreg_b32 s82, hwreg(HW_REG_IB_STS, 8, 4)
    s_cmp_lg_u32 s82, 0
    s_cselect_b32 s82, -1, 0
    s_add_u32 s95, s95, s82
    s_add_u32 s86, s86, 128
    s_add_u32 s87, s87, 128
L_nop1:
    v_and_b32_dpp v12, v21, v2 row_newbcast:0 row_mask:0xf bank_mask:0xf
    v_and_b32_dpp v13, v21, v3 row_newbcast:0 row_mask:0xf bank_mask:0xf
    v_and_b32_dpp v14, v21, v4 row_newbcast:0 row_mask:0xf bank_mask:0xf
    v_and_b32_dpp v15, v21, v5 row_newbcast:0 row_mask:0xf bank_mask:0xf
    s_waitcnt vmcnt(3)
    s_add_u32 s83, s77, s97
    buffer_load_dwordx4 v[108:111], v28, s[12:15], s83 offen
    s_add_u32 s97, s97, 0x8000
    s_and_b32 s97, s97, 0xfffff
    v_mfma_f32_16x16x32_bf16 v[8:11], v[92:95], v[16:19], v[8:11]
    v_and_b32_dpp v16, v21, v2 row_newbcast:1 row_mask:0xf bank_mask:0xf
    v_and_b32_dpp v17, v21, v3 row_newbcast:1 row_mask:0xf bank_mask:0xf
    v_and_b32_dpp v18, v21, v4 row_newbcast:1 row_mask:0xf bank_mask:0xf
    v_and_b32_dpp v19, v21, v5 row_newbcast:1 row_mask:0xf bank_mask:0xf
    s_waitcnt vmcnt(3)
    s_add_u32 s83, s77, s97
    buffer_load_dwordx4 v[112:115], v28, s[12:15], s83 offen
    s_add_u32 s97, s97, 0x8000
    s_and_b32 s97, s97, 0xfffff
    v_mfma_f32_16x16x32_bf16 v[8:11], v[96:99], v[12:15], v[8:11]
    v_and_b32_dpp v12, v21, v2 row_newbcast:2 row_mask:0xf bank_mask:0xf
    v_and_b32_dpp v13, v21, v3 row_newbcast:2 row_mask:0xf bank_mask:0xf
    v_and_b32_dpp v14, v21, v4 row_newbcast:2 row_mask:0xf bank_mask:0xf
    v_and_b32_dpp v15, v21, v5 row_newbcast:2 row_mask:0xf bank_mask:0xf
    s_waitcnt vmcnt(3)
    s_add_u32 s83, s77, s97
    buffer_load_dwordx4 v[116:119], v28, s[12:15], s83 offen
    s_add_u32 s97, s97, 0x8000
    s_and_b32 s97, s97, 0xfffff
    v_mfma_f32_16x16x32_bf16 v[8:11], v[100:103], v[16:19], v[8:11]
    v_and_b32_dpp v16, v21, v2 row_newbcast:3 row_mask:0xf bank_mask:0xf
    v_and_b32_dpp v17, v21, v3 row_newbcast:3 row_mask:0xf bank_mask:0xf
    v_and_b32_dpp v18, v21, v4 row_newbcast:3 row_mask:0xf bank_mask:0xf
    v_and_b32_dpp v19, v21, v5 row_newbcast:3 row_mask:0xf bank_mask:0xf
    s_waitcnt vmcnt(3)
    s_add_u32 s83, s77, s97
    buffer_load_dwordx4 v[120:123], v28, s[12:15], s83 offen
    s_add_u32 s97, s97, 0x8000
    s_and_b32 s97, s97, 0xfffff
    v_mfma_f32_16x16x32_bf16 v[8:11], v[104:107], v[12:15], v[8:11]
    v_and_b32_dpp v12, v21, v2 row_newbcast:4 row_mask:0xf bank_mask:0xf
    v_and_b32_dpp v13, v21, v3 row_newbcast:4 row_mask:0xf bank_mask:0xf
    v_and_b32_dpp v14, v21, v4 row_newbcast:4 row_mask:0xf bank_mask:0xf
    v_and_b32_dpp v15, v21, v5 row_newbcast:4 row_mask:0xf bank_mask:0xf
    s_waitcnt vmcnt(3)
    s_add_u32 s83, s77, s97
    buffer_load_dwordx4 v[124:127], v28, s[12:15], s83 offen
    s_add_u32 s97, s97, 0x8000
    s_and_b32 s97, s97, 0xfffff
    v_mfma_f32_16x16x32_bf16 v[8:11], v[108:111], v[16:19], v[8:11]
    v_and_b32_dpp v16, v21, v2 row_newbcast:5 row_mask:0xf bank_mask:0xf
    v_and_b32_dpp v17, v21, v3 row_newbcast:5 row_mask:0xf bank_mask:0xf
    v_and_b32_dpp v18, v21, v4 row_newbcast:5 row_mask:0xf bank_mask:0xf
    v_and_b32_dpp v19, v21, v5 row_newbcast:5 row_mask:0xf bank_mask:0xf
    s_waitcnt vmcnt(3)
    s_add_u32 s83, s77, s97
    buffer_load_dwordx4 v[128:131], v28, s[12:15], s83 offen
    s_add_u32 s97, s97, 0x8000
    s_and_b32 s97, s97, 0xfffff
    v_mfma_f32_16x16x32_bf16 v[8:11], v[112:115], v[12:15], v[8:11]
    v_and_b32_dpp v12, v21, v2 row_newbcast:6 row_mask:0xf bank_mask:0xf
    v_and_b32_dpp v13, v21, v3 row_newbcast:6 row_mask:0xf bank_mask:0xf
    v_and_b32_dpp v14, v21, v4 row_newbcast:6 row_mask:0xf bank_mask:0xf
    v_and_b32_dpp v15, v21, v5 row_newbcast:6 row_mask:0xf bank_mask:0xf
    s_waitcnt vmcnt(3)
    s_add_u32 s83, s77, s97
    buffer_load_dwordx4 v[132:135], v28, s[12:15], s83 offen
    s_add_u32 s97, s97, 0x8000
    s_and_b32 s97, s97, 0xfffff
    v_mfma_f32_16x16x32_bf16 v[8:11], v[116:119], v[16:19], v[8:11]
    v_and_b32_dpp v16, v21, v2 row_newbcast:7 row_mask:0xf bank_mask:0xf
    v_and_b32_dpp v17, v21, v3 row_newbcast:7 row_mask:0xf bank_mask:0xf
    v_and_b32_dpp v18, v21, v4 row_newbcast:7 row_mask:0xf bank_mask:0xf
    v_and_b32_dpp v19, v21, v5 row_newbcast:7 row_mask:0xf bank_mask:0xf
    s_waitcnt vmcnt(3)
    s_add_u32 s83, s77, s97
    buffer_load_dwordx4 v[136:139], v28, s[12:15], s83 offen
    s_add_u32 s97, s97, 0x8000
    s_and_b32 s97, s97, 0xfffff
    v_mfma_f32_16x16x32_bf16 v[8:11], v[120:123], v[12:15], v[8:11]
    v_and_b32_dpp v12, v21, v2 row_newbcast:8 row_mask:0xf bank_mask:0xf
    v_and_b32_dpp v13, v21, v3 row_newbcast:8 row_mask:0xf bank_mask:0xf
    v_and_b32_dpp v14, v21, v4 row_newbcast:8 row_mask:0xf bank_mask:0xf
    v_and_b32_dpp v15, v21, v5 row_newbcast:8 row_mask:0xf bank_mask:0xf
    s_waitcnt vmcnt(3)
    s_add_u32 s83, s77, s97
    buffer_load_dwordx4 v[140:143], v28, s[12:15], s83 offen
    s_add_u32 s97, s97, 0x8000
    s_and_b32 s97, s97, 0xfffff
    v_mfma_f32_16x16x32_bf16 v[8:11], v[124:127], v[16:19], v[8:11]
    v_and_b32_dpp v16, v21, v2 row_newbcast:9 row_mask:0xf bank_mask:0xf
    v_and_b32_dpp v17, v21, v3 row_newbcast:9 row_mask:0xf bank_mask:0xf
    v_and_b32_dpp v18, v21, v4 row_newbcast:9 row_mask:0xf bank_mask:0xf
    v_and_b32_dpp v19, v21, v5 row_newbcast:9 row_mask:0xf bank_mask:0xf
    s_waitcnt vmcnt(3)
    s_add_u32 s83, s77, s97
    buffer_load_dwordx4 v[144:147], v28, s[12:15], s83 offen
    s_add_u32 s97, s97, 0x8000
    s_and_b32 s97, s97, 0xfffff
    v_mfma_f32_16x16x32_bf16 v[8:11], v[128:131], v[12:15], v[8:11]
    v_and_b32_dpp v12, v21, v2 row_newbcast:10 row_mask:0xf bank_mask:0xf
    v_and_b32_dpp v13, v21, v3 row_newbcast:10 row_mask:0xf bank_mask:0xf
    v_and_b32_dpp v14, v21, v4 row_newbcast:10 row_mask:0xf bank_mask:0xf
    v_and_b32_dpp v15, v21, v5 row_newbcast:10 row_mask:0xf bank_mask:0xf
    s_waitcnt vmcnt(3)
    s_add_u32 s83, s77, s97
    buffer_load_dwordx4 v[148:151], v28, s[12:15], s83 offen
    s_add_u32 s97, s97, 0x8000
    s_and_b32 s97, s97, 0xfffff
    v_mfma_f32_16x16x32_bf16 v[8:11], v[132:135], v[16:19], v[8:11]
    v_and_b32_dpp v16, v21, v2 row_newbcast:11 row_mask:0xf bank_mask:0xf
    v_and_b32_dpp v17, v21, v3 row_newbcast:11 row_mask:0xf bank_mask:0xf
    v_and_b32_dpp v18, v21, v4 row_newbcast:11 row_mask:0xf bank_mask:0xf
    v_and_b32_dpp v19, v21, v5 row_newbcast:11 row_mask:0xf bank_mask:0xf
    s_waitcnt vmcnt(3)
    s_add_u32 s83, s77, s97
    buffer_load_dwordx4 v[152:155], v28, s[12:15], s83 offen
    s_add_u32 s97, s97, 0x8000
    s_and_b32 s97, s97, 0xfffff
    v_mfma_f32_16x16x32_bf16 v[8:11], v[136:139], v[12:15], v[8:11]
    v_and_b32_dpp v12, v21, v2 row_newbcast:12 row_mask:0xf bank_mask:0xf
    v_and_b32_dpp v13, v21, v3 row_newbcast:12 row_mask:0xf bank_mask:0xf
    v_and_b32_dpp v14, v21, v4 row_newbcast:12 row_mask:0xf bank_mask:0xf
    v_and_b32_dpp v15, v21, v5 row_newbcast:12 row_mask:0xf bank_mask:0xf
    s_waitcnt vmcnt(3)
    s_add_u32 s83, s77, s97
    buffer_load_dwordx4 v[156:159], v28, s[12:15], s83 offen
    s_add_u32 s97, s97, 0x8000
    s_and_b32 s97, s97, 0xfffff
    v_mfma_f32_16x16x32_bf16 v[8:11], v[140:143], v[16:19], v[8:11]
    v_and_b32_dpp v16, v21, v2 row_newbcast:13 row_mask:0xf bank_mask:0xf
    v_and_b32_dpp v17, v21, v3 row_newbcast:13 row_mask:0xf bank_mask:0xf
    v_and_b32_dpp v18, v21, v4 row_newbcast:13 row_mask:0xf bank_mask:0xf
    v_and_b32_dpp v19, v21, v5 row_newbcast:13 row_mask:0xf bank_mask:0xf
    s_waitcnt vmcnt(3)
    v_mfma_f32_16x16x32_bf16 v[8:11], v[144:147], v[12:15], v[8:11]
    v_and_b32_dpp v12, v21, v2 row_newbcast:14 row_mask:0xf bank_mask:0xf
    v_and_b32_dpp v13, v21, v3 row_newbcast:14 row_mask:0xf bank_mask:0xf
    v_and_b32_dpp v14, v21, v4 row_newbcast:14 row_mask:0xf bank_mask:0xf
    v_and_b32_dpp v15, v21, v5 row_newbcast:14 row_mask:0xf bank_mask:0xf
    s_waitcnt vmcnt(2)
    v_mfma_f32_16x16x32_bf16 v[8:11], v[148:151], v[16:19], v[8:11]
    v_and_b32_dpp v16, v21, v2 row_newbcast:15 row_mask:0xf bank_mask:0xf
    v_and_b32_dpp v17, v21, v3 row_newbcast:15 row_mask:0xf bank_mask:0xf
    v_and_b32_dpp v18, v21, v4 row_newbcast:15 row_mask:0xf bank_mask:0xf
    v_and_b32_dpp v19, v21, v5 row_newbcast:15 row_mask:0xf bank_mask:0xf
    s_waitcnt vmcnt(1)
    v_mfma_f32_16x16x32_bf16 v[8:11], v[152:155], v[12:15], v[8:11]
    s_waitcnt vmcnt(0)
    v_mfma_f32_16x16x32_bf16 v[8:11], v[156:159], v[16:19], v[8:11]
    s_nop 7
    ds_write_b32 v6, v8 offset:0
    ds_write_b32 v6, v9 offset:128
    ds_write_b32 v6, v10 offset:256
    ds_write_b32 v6, v11 offset:384
    s_lshl_b32 s83, s72, 2
    v_mov_b32 v1, s83
    v_mov_b32 v7, 0
    ds_write_b32 v1, v7 offset:7216
    s_and_b32 s86, s81, 1
    s_mul_i32 s96, s86, 43
    s_add_u32 s97, s96, 44
    s_add_u32 s96, s96, 1
    s_lshr_b32 s96, s96, 1
    s_lshr_b32 s97, s97, 1
    s_sub_u32 s78, s2, 64
    s_mov_b32 s88, 0xffff0000
    s_mov_b32 s89, 0xffff0000
    s_mov_b32 s90, 0x00ff00ff
    s_mov_b32 s91, 0x00ff00ff
    s_mov_b32 s84, 0x05040100
    s_mov_b32 s85, 0x07060302
    s_mov_b32 s94, 0x3fb8aa3b
    v_mov_b32 v23, -2
    s_mov_b32 s16, s56
    s_mov_b32 s17, s57
    s_mov_b32 s18, 4194304
    s_mov_b32 s19, 0x20000
    s_mov_b32 s40, s66
    s_mov_b32 s41, s67
    s_mov_b32 s42, 2048
    s_mov_b32 s43, 0x20000
    s_mov_b32 s44, s68
    s_mov_b32 s45, s69
    s_mov_b32 s46, 256
    s_mov_b32 s47, 0x20000
    s_mov_b32 s28, s60
    s_mov_b32 s29, s61
    s_mov_b32 s30, 1409024
    s_mov_b32 s31, 0x20000
    s_mov_b32 s32, s62
    s_mov_b32 s33, s63
    s_mov_b32 s34, 1409024
    s_mov_b32 s35, 0x20000
    s_mov_b32 s36, s64
    s_mov_b32 s37, s65
    s_mov_b32 s38, 1409024
    s_mov_b32 s39, 0x20000
    v_lshrrev_b32 v162, 2, v161
    s_lshl_b32 s83, s72, 2
    v_add_u32 v162, s83, v162
    v_and_b32 v163, 3, v161
    v_lshlrev_b32 v163, 4, v163
    v_and_b32 v1, 1, v160
    v_lshl_add_u32 v20, v162, 1, v1
    s_lshl_b32 s83, s74, 5
    v_add_u32 v20, s83, v20
    v_lshlrev_b32 v1, 5, v1
    v_lshl_add_u32 v21, v162, 1, v1
    v_lshrrev_b32 v1, 1, v160
    v_add_u32 v21, v21, v1
    s_lshl_b32 s82, s73, 2
    s_add_u32 s82, s82, s75
    s_lshl_b32 s83, s82, 6
    v_add_u32 v24, s83, v163
    s_lshl_b32 s76, s82, 3
    s_lshl_b32 s81, s74, 15
    s_add_u32 s76, s76, s81
    s_add_u32 s76, s76, 151552
    v_add_u32 v25, 0x4000, v163
    v_lshlrev_b32 v20, 2, v20
    v_lshlrev_b32 v21, 2, v21
    s_lshr_b32 s93, s93, 3
    v_and_b32 v1, 3, v161
    v_mul_u32_u24 v1, 272, v1
    v_lshl_add_u32 v1, v160, 4, v1
    s_add_u32 s83, s93, 0
    s_and_b32 s83, s83, 3
    s_lshl_b32 s83, s83, 6
    v_add_u32 v2, s83, v1
    s_add_u32 s83, s93, 1
    s_and_b32 s83, s83, 3
    s_lshl_b32 s83, s83, 6
    v_add_u32 v3, s83, v1
    s_add_u32 s83, s93, 2
    s_and_b32 s83, s83, 3
    s_lshl_b32 s83, s83, 6
    v_add_u32 v4, s83, v1
    s_add_u32 s83, s93, 3
    s_and_b32 s83, s83, 3
    s_lshl_b32 s83, s83, 6
    v_add_u32 v5, s83, v1
    v_lshlrev_b32 v1, 4, v161
    v_lshl_add_u32 v28, v160, 11, v1
    v_lshl_add_u32 v6, v160, 13, v1
    v_mov_b32 v26, 0
    v_mov_b32 v27, 0
    v_mov_b32 v22, 0
    s_cmp_lt_u32 s79, 64
    s_cbranch_scc0 L_nored1
    s_lshl_b32 s81, s79, 5
    v_lshrrev_b32 v1, 5, v0
    v_and_b32 v167, 3, v0
    s_lshr_b32 s82, s79, 1
    s_lshl_b32 s82, s82, 6
    s_and_b32 s83, s79, 1
    s_lshl_b32 s83, s83, 3
    s_add_u32 s82, s82, s83
    v_lshlrev_b32 v27, 4, v167
    v_lshl_add_u32 v27, v1, 2, v27
    v_add_u32 v27, s82, v27
    s_add_u32 s81, s81, 0x5000
    v_lshlrev_b32 v26, 2, v167
    v_lshl_add_u32 v26, v1, 4, v26
    v_bfe_u32 v1, v0, 2, 3
    v_add_u32 v26, s81, v26
    v_lshlrev_b32 v21, 2, v1
    buffer_load_dword v22, v27, s[24:27], 0 offen
    v_lshlrev_b32 v1, 4, v0
    v_mov_b32 v7, s95
    s_mov_b32 s82, s3
    buffer_store_dwordx4 v[168:171], v1, s[20:23], s82 offen offset:0 sc1
    buffer_store_dwordx4 v[168:171], v1, s[20:23], s82 offen offset:1024 sc1
    buffer_store_dwordx4 v[168:171], v1, s[20:23], s82 offen offset:2048 sc1
    buffer_store_dwordx4 v[168:171], v1, s[20:23], s82 offen offset:3072 sc1
    s_add_u32 s82, s82, 4096
    buffer_store_dwordx4 v[168:171], v1, s[20:23], s82 offen offset:0 sc1
    buffer_store_dwordx4 v[168:171], v1, s[20:23], s82 offen offset:1024 sc1
    buffer_store_dwordx4 v[168:171], v1, s[20:23], s82 offen offset:2048 sc1
    buffer_store_dwordx4 v[168:171], v1, s[20:23], s82 offen offset:3072 sc1
    s_add_u32 s82, s82, 12288
    buffer_store_dwordx4 v[168:171], v1, s[20:23], s82 offen offset:0 sc1
    buffer_store_dwordx4 v[168:171], v1, s[20:23], s82 offen offset:1024 sc1
    buffer_store_dwordx4 v[168:171], v1, s[20:23], s82 offen offset:2048 sc1
    buffer_store_dwordx4 v[168:171], v1, s[20:23], s82 offen offset:3072 sc1
    s_add_u32 s82, s82, 4096
    s_cmp_lt_u32 s79, 10
    s_cbranch_scc0 L_noclr2
    buffer_store_dwordx4 v[168:171], v1, s[20:23], s82 offen offset:0 sc1
    buffer_store_dwordx4 v[168:171], v1, s[20:23], s82 offen offset:1024 sc1
L_noclr2:
    s_lshl_b32 s81, s79, 2
    s_waitcnt vmcnt(0)
    s_mov_b64 exec, 1
    buffer_store_dword v7, v1, s[44:47], s81 offen sc1
    s_mov_b64 exec, -1
    s_waitcnt vmcnt(0)
L_nored1:
    s_lshl_b32 s77, s73, 17
    s_lshl_b32 s83, s72, 8
    s_add_u32 s77, s77, s83
    s_add_u32 s82, s93, 0
    s_and_b32 s82, s82, 3
    s_lshl_b32 s82, s82, 15
    s_add_u32 s82, s82, s77
    buffer_load_dwordx4 v[160:163], v28, s[16:19], s82 offen offset:0
    buffer_load_dwordx4 v[176:179], v28, s[16:19], s82 offen offset:1024
    s_add_u32 s82, s82, 0x2000
    buffer_load_dwordx4 v[164:167], v28, s[16:19], s82 offen offset:0
    buffer_load_dwordx4 v[180:183], v28, s[16:19], s82 offen offset:1024
    s_add_u32 s82, s82, 0x2000
    s_waitcnt vmcnt(3)
    buffer_load_dwordx4 v[168:171], v28, s[16:19], s82 offen offset:0
    s_waitcnt vmcnt(3)
    buffer_load_dwordx4 v[184:187], v28, s[16:19], s82 offen offset:1024
    s_add_u32 s82, s82, 0x2000
    s_waitcnt vmcnt(3)
    buffer_load_dwordx4 v[172:175], v28, s[16:19], s82 offen offset:0
    s_waitcnt vmcnt(3)
    buffer_load_dwordx4 v[188:191], v28, s[16:19], s82 offen offset:1024
    s_add_u32 s82, s93, 1
    s_and_b32 s82, s82, 3
    s_lshl_b32 s82, s82, 15
    s_add_u32 s82, s82, s77
    s_waitcnt vmcnt(3)
    buffer_load_dwordx4 v[192:195], v28, s[16:19], s82 offen offset:0
    s_waitcnt vmcnt(3)
    buffer_load_dwordx4 v[208:211], v28, s[16:19], s82 offen offset:1024
    s_add_u32 s82, s82, 0x2000
    s_waitcnt vmcnt(3)
    buffer_load_dwordx4 v[196:199], v28, s[16:19], s82 offen offset:0
    s_waitcnt vmcnt(3)
    buffer_load_dwordx4 v[212:215], v28, s[16:19], s82 offen offset:1024
    s_add_u32 s82, s82, 0x2000
    s_waitcnt vmcnt(3)
    buffer_load_dwordx4 v[200:203], v28, s[16:19], s82 offen offset:0
    s_waitcnt vmcnt(3)
    buffer_load_dwordx4 v[216:219], v28, s[16:19], s82 offen offset:1024
    s_add_u32 s82, s82, 0x2000
    s_waitcnt vmcnt(3)
    buffer_load_dwordx4 v[204:207], v28, s[16:19], s82 offen offset:0
    s_waitcnt vmcnt(3)
    buffer_load_dwordx4 v[220:223], v28, s[16:19], s82 offen offset:1024
    s_add_u32 s82, s93, 2
    s_and_b32 s82, s82, 3
    s_lshl_b32 s82, s82, 15
    s_add_u32 s82, s82, s77
    s_waitcnt vmcnt(3)
    buffer_load_dwordx4 v[224:227], v28, s[16:19], s82 offen offset:0
    s_waitcnt vmcnt(3)
    buffer_load_dwordx4 v[240:243], v28, s[16:19], s82 offen offset:1024
    s_add_u32 s82, s82, 0x2000
    s_waitcnt vmcnt(3)
    buffer_load_dwordx4 v[228:231], v28, s[16:19], s82 offen offset:0
    s_waitcnt vmcnt(3)
    buffer_load_dwordx4 v[244:247], v28, s[16:19], s82 offen offset:1024
    s_add_u32 s82, s82, 0x2000
    s_waitcnt vmcnt(3)
    buffer_load_dwordx4 v[232:235], v28, s[16:19], s82 offen offset:0
    s_waitcnt vmcnt(3)
    buffer_load_dwordx4 v[248:251], v28, s[16:19], s82 offen offset:1024
    s_add_u32 s82, s82, 0x2000
    s_waitcnt vmcnt(3)
    buffer_load_dwordx4 v[236:239], v28, s[16:19], s82 offen offset:0
    s_waitcnt vmcnt(3)
    buffer_load_dwordx4 v[252:255], v28, s[16:19], s82 offen offset:1024
    s_waitcnt vmcnt(16)
    v_perm_b32 v32, v164, v160, s84
    v_perm_b32 v33, v172, v168, s84
    v_perm_b32 v34, v180, v176, s84
    v_perm_b32 v35, v188, v184, s84
    v_perm_b32 v48, v164, v160, s85
    v_perm_b32 v49, v172, v168, s85
    v_perm_b32 v50, v180, v176, s85
    v_perm_b32 v51, v188, v184, s85
    v_perm_b32 v64, v165, v161, s84
    v_perm_b32 v65, v173, v169, s84
    v_perm_b32 v66, v181, v177, s84
    v_perm_b32 v67, v189, v185, s84
    v_perm_b32 v80, v165, v161, s85
    v_perm_b32 v81, v173, v169, s85
    v_perm_b32 v82, v181, v177, s85
    v_perm_b32 v83, v189, v185, s85
    v_perm_b32 v96, v166, v162, s84
    v_perm_b32 v97, v174, v170, s84
    v_perm_b32 v98, v182, v178, s84
    v_perm_b32 v99, v190, v186, s84
    v_perm_b32 v112, v166, v162, s85
    v_perm_b32 v113, v174, v170, s85
    v_perm_b32 v114, v182, v178, s85
    v_perm_b32 v115, v190, v186, s85
    v_perm_b32 v128, v167, v163, s84
    v_perm_b32 v129, v175, v171, s84
    v_perm_b32 v130, v183, v179, s84
    v_perm_b32 v131, v191, v187, s84
    v_perm_b32 v144, v167, v163, s85
    v_perm_b32 v145, v175, v171, s85
    v_perm_b32 v146, v183, v179, s85
    v_perm_b32 v147, v191, v187, s85
    s_add_u32 s82, s93, 3
    s_and_b32 s82, s82, 3
    s_lshl_b32 s82, s82, 15
    s_add_u32 s82, s82, s77
    s_waitcnt vmcnt(3)
    buffer_load_dwordx4 v[160:163], v28, s[16:19], s82 offen offset:0
    s_waitcnt vmcnt(3)
    buffer_load_dwordx4 v[176:179], v28, s[16:19], s82 offen offset:1024
    s_add_u32 s82, s82, 0x2000
    s_waitcnt vmcnt(3)
    buffer_load_dwordx4 v[164:167], v28, s[16:19], s82 offen offset:0
    s_waitcnt vmcnt(3)
    buffer_load_dwordx4 v[180:183], v28, s[16:19], s82 offen offset:1024
    s_add_u32 s82, s82, 0x2000
    s_waitcnt vmcnt(3)
    buffer_load_dwordx4 v[168:171], v28, s[16:19], s82 offen offset:0
    s_waitcnt vmcnt(3)
    buffer_load_dwordx4 v[184:187], v28, s[16:19], s82 offen offset:1024
    s_add_u32 s82, s82, 0x2000
    s_waitcnt vmcnt(3)
    buffer_load_dwordx4 v[172:175], v28, s[16:19], s82 offen offset:0
    s_waitcnt vmcnt(3)
    buffer_load_dwordx4 v[188:191], v28, s[16:19], s82 offen offset:1024
    s_waitcnt vmcnt(16)
    v_perm_b32 v36, v196, v192, s84
    v_perm_b32 v37, v204, v200, s84
    v_perm_b32 v38, v212, v208, s84
    v_perm_b32 v39, v220, v216, s84
    v_perm_b32 v52, v196, v192, s85
    v_perm_b32 v53, v204, v200, s85
    v_perm_b32 v54, v212, v208, s85
    v_perm_b32 v55, v220, v216, s85
    v_perm_b32 v68, v197, v193, s84
    v_perm_b32 v69, v205, v201, s84
    v_perm_b32 v70, v213, v209, s84
    v_perm_b32 v71, v221, v217, s84
    v_perm_b32 v84, v197, v193, s85
    v_perm_b32 v85, v205, v201, s85
    v_perm_b32 v86, v213, v209, s85
    v_perm_b32 v87, v221, v217, s85
    v_perm_b32 v100, v198, v194, s84
    v_perm_b32 v101, v206, v202, s84
    v_perm_b32 v102, v214, v210, s84
    v_perm_b32 v103, v222, v218, s84
    v_perm_b32 v116, v198, v194, s85
    v_perm_b32 v117, v206, v202, s85
    v_perm_b32 v118, v214, v210, s85
    v_perm_b32 v119, v222, v218, s85
    v_perm_b32 v132, v199, v195, s84
    v_perm_b32 v133, v207, v203, s84
    v_perm_b32 v134, v215, v211, s84
    v_perm_b32 v135, v223, v219, s84
    v_perm_b32 v148, v199, v195, s85
    v_perm_b32 v149, v207, v203, s85
    v_perm_b32 v150, v215, v211, s85
    v_perm_b32 v151, v223, v219, s85
    s_waitcnt vmcnt(8)
    v_perm_b32 v40, v228, v224, s84
    v_perm_b32 v41, v236, v232, s84
    v_perm_b32 v42, v244, v240, s84
    v_perm_b32 v43, v252, v248, s84
    v_perm_b32 v56, v228, v224, s85
    v_perm_b32 v57, v236, v232, s85
    v_perm_b32 v58, v244, v240, s85
    v_perm_b32 v59, v252, v248, s85
    v_perm_b32 v72, v229, v225, s84
    v_perm_b32 v73, v237, v233, s84
    v_perm_b32 v74, v245, v241, s84
    v_perm_b32 v75, v253, v249, s84
    v_perm_b32 v88, v229, v225, s85
    v_perm_b32 v89, v237, v233, s85
    v_perm_b32 v90, v245, v241, s85
    v_perm_b32 v91, v253, v249, s85
    v_perm_b32 v104, v230, v226, s84
    v_perm_b32 v105, v238, v234, s84
    v_perm_b32 v106, v246, v242, s84
    v_perm_b32 v107, v254, v250, s84
    v_perm_b32 v120, v230, v226, s85
    v_perm_b32 v121, v238, v234, s85
    v_perm_b32 v122, v246, v242, s85
    v_perm_b32 v123, v254, v250, s85
    v_perm_b32 v136, v231, v227, s84
    v_perm_b32 v137, v239, v235, s84
    v_perm_b32 v138, v247, v243, s84
    v_perm_b32 v139, v255, v251, s84
    v_perm_b32 v152, v231, v227, s85
    v_perm_b32 v153, v239, v235, s85
    v_perm_b32 v154, v247, v243, s85
    v_perm_b32 v155, v255, v251, s85
    s_waitcnt vmcnt(0)
    v_perm_b32 v44, v164, v160, s84
    v_perm_b32 v45, v172, v168, s84
    v_perm_b32 v46, v180, v176, s84
    v_perm_b32 v47, v188, v184, s84
    v_perm_b32 v60, v164, v160, s85
    v_perm_b32 v61, v172, v168, s85
    v_perm_b32 v62, v180, v176, s85
    v_perm_b32 v63, v188, v184, s85
    v_perm_b32 v76, v165, v161, s84
    v_perm_b32 v77, v173, v169, s84
    v_perm_b32 v78, v181, v177, s84
    v_perm_b32 v79, v189, v185, s84
    v_perm_b32 v92, v165, v161, s85
    v_perm_b32 v93, v173, v169, s85
    v_perm_b32 v94, v181, v177, s85
    v_perm_b32 v95, v189, v185, s85
    v_perm_b32 v108, v166, v162, s84
    v_perm_b32 v109, v174, v170, s84
    v_perm_b32 v110, v182, v178, s84
    v_perm_b32 v111, v190, v186, s84
    v_perm_b32 v124, v166, v162, s85
    v_perm_b32 v125, v174, v170, s85
    v_perm_b32 v126, v182, v178, s85
    v_perm_b32 v127, v190, v186, s85
    v_perm_b32 v140, v167, v163, s84
    v_perm_b32 v141, v175, v171, s84
    v_perm_b32 v142, v183, v179, s84
    v_perm_b32 v143, v191, v187, s84
    v_perm_b32 v156, v167, v163, s85
    v_perm_b32 v157, v175, v171, s85
    v_perm_b32 v158, v183, v179, s85
    v_perm_b32 v159, v191, v187, s85
    v_and_b32 v1, 3, v0
    v_lshlrev_b32 v1, 3, v1
    s_mov_b32 s92, 0
L_ml_spin:
    ds_read_b64 v[12:13], v1 offset:7168
    s_waitcnt lgkmcnt(0)
    v_max_u32 v14, v12, v13
    v_cmp_eq_u32 vcc, -1, v14
    s_cbranch_vccz L_ml_ok
    s_sleep 16
    s_add_u32 s92, s92, 1
    s_cmp_lt_u32 s92, 65536
    s_cbranch_scc1 L_ml_spin
    s_mov_b64 exec, -1
L_ml_ok:
    s_nop 1
    v_max_f32_dpp v14, v12, v12 quad_perm:[1,0,3,2] row_mask:0xf bank_mask:0xf
    s_nop 1
    v_max_f32_dpp v14, v14, v14 quad_perm:[2,3,0,1] row_mask:0xf bank_mask:0xf
    v_sub_f32 v16, v12, v14
    v_mul_f32 v16, s94, v16
    v_exp_f32 v16, v16
    s_nop 0
    v_mul_f32 v15, v16, v13
    s_nop 1
    v_add_f32_dpp v15, v15, v15 quad_perm:[1,0,3,2] row_mask:0xf bank_mask:0xf
    s_nop 1
    v_add_f32_dpp v15, v15, v15 quad_perm:[2,3,0,1] row_mask:0xf bank_mask:0xf
    v_readlane_b32 s8, v16, 0
    v_readlane_b32 s9, v16, 1
    v_readlane_b32 s10, v16, 2
    v_readlane_b32 s11, v16, 3
    v_min_u32 v14, -2, v14
    v_min_u32 v15, -2, v15
    v_lshlrev_b32 v1, 2, v0
    buffer_load_dword v12, v1, s[44:47], 0 offen
    s_mov_b32 s92, 0
L_fl_spin:
    s_waitcnt vmcnt(0)
    v_cmp_eq_u32 vcc, 0, v12
    s_cbranch_vccz L_fl_ok
    s_sleep 32
    buffer_load_dword v12, v1, s[44:47], 0 offen sc1
    s_add_u32 s92, s92, 1
    s_cmp_lt_u32 s92, 65536
    s_cbranch_scc1 L_fl_spin
    s_mov_b64 exec, -1
L_fl_ok:
    s_nop 1
    s_waitcnt vmcnt(0)
    v_add_u32_dpp v12, v12, v12 row_ror:4 row_mask:0xf bank_mask:0xf
    s_nop 1
    v_add_u32_dpp v12, v12, v12 row_ror:8 row_mask:0xf bank_mask:0xf
    v_mov_b32 v17, v12
    s_nop 1
    v_permlane16_swap_b32 v12, v17
    v_add_u32 v12, v12, v17
    v_mov_b32 v17, v12
    s_nop 1
    v_permlane32_swap_b32 v12, v17
    v_add_u32 v12, v12, v17
    v_cmp_gt_u32 vcc, 256, v12
    s_nop 1
    v_cndmask_b32_e64 v12, 0, 4, vcc
    v_xor_b32 v12, v12, v0
    v_and_b32 v12, 4, v12
    v_lshlrev_b32 v12, 11, v12
    v_lshrrev_b32 v17, 3, v0
    v_lshl_add_u32 v12, v17, 17, v12
    v_and_b32 v17, 3, v0
    v_lshl_add_u32 v12, v17, 15, v12
    ds_bpermute_b32 v17, v20, v12
    ds_bpermute_b32 v18, v21, v12
    s_and_b32 s81, s2, 7
    v_readlane_b32 s95, v12, s81
    s_and_b32 s81, s79, 63
    v_readlane_b32 s3, v12, s81
    s_add_u32 s95, s95, 0x5000
    s_waitcnt lgkmcnt(0)
    v_add_u32 v24, v24, v17
    v_add_u32 v25, v25, v18
    v_add_u32 v26, v26, v18
    s_cmp_eq_u32 s72, 0
    s_cbranch_scc0 L_nopub
    v_mov_b32 v1, 0
    s_mov_b64 exec, 1
    buffer_store_dwordx2 v[14:15], v1, s[20:23], s76 offen sc1
    s_mov_b64 exec, -1
    s_cmp_lt_u32 s79, 64
    s_cbranch_scc0 L_nopub
    v_lshrrev_b32 v1, 2, v0
    v_lshlrev_b32 v1, 3, v1
    s_lshr_b32 s81, s79, 5
    s_lshl_b32 s81, s81, 15
    s_add_u32 s81, s81, 151552
    s_mov_b32 s92, 0
    v_mov_b32 v13, 0
L_lw_spin:
    ds_read_b32 v12, v13 offset:7200
    s_waitcnt lgkmcnt(0)
    v_cmp_eq_u32 vcc, -1, v12
    s_cbranch_vccz L_lw_ok
    s_sleep 16
    s_add_u32 s92, s92, 1
    s_cmp_lt_u32 s92, 65536
    s_cbranch_scc1 L_lw_spin
    s_mov_b64 exec, -1
L_lw_ok:
    s_nop 1
    s_mov_b32 s92, 0
L_mc_spin:
    buffer_load_dwordx2 v[224:225], v1, s[20:23], s81 offen offset:0 sc1
    buffer_load_dwordx2 v[226:227], v1, s[20:23], s81 offen offset:128 sc1
    buffer_load_dwordx2 v[228:229], v1, s[20:23], s81 offen offset:256 sc1
    buffer_load_dwordx2 v[230:231], v1, s[20:23], s81 offen offset:384 sc1
    buffer_load_dwordx2 v[232:233], v1, s[20:23], s81 offen offset:512 sc1
    buffer_load_dwordx2 v[234:235], v1, s[20:23], s81 offen offset:640 sc1
    buffer_load_dwordx2 v[236:237], v1, s[20:23], s81 offen offset:768 sc1
    buffer_load_dwordx2 v[238:239], v1, s[20:23], s81 offen offset:896 sc1
    s_waitcnt vmcnt(0)
    v_max3_u32 v12, v224, v225, v226
    v_max3_u32 v12, v12, v227, v228
    v_max3_u32 v12, v12, v229, v230
    v_max3_u32 v12, v12, v231, v232
    v_max3_u32 v12, v12, v233, v234
    v_max3_u32 v12, v12, v235, v236
    v_max3_u32 v12, v12, v237, v238
    v_max_u32 v12, v12, v239
    v_cmp_eq_u32 vcc, -1, v12
    s_cbranch_vccz L_mc_ok
    s_sleep 16
    s_add_u32 s92, s92, 1
    s_cmp_lt_u32 s92, 65536
    s_cbranch_scc1 L_mc_spin
    s_mov_b64 exec, -1
L_mc_ok:
    s_nop 1
    v_max_f32_dpp v240, v224, v224 row_ror:4 row_mask:0xf bank_mask:0xf
    v_max_f32_dpp v241, v226, v226 row_ror:4 row_mask:0xf bank_mask:0xf
    v_max_f32_dpp v242, v228, v228 row_ror:4 row_mask:0xf bank_mask:0xf
    v_max_f32_dpp v243, v230, v230 row_ror:4 row_mask:0xf bank_mask:0xf
    v_max_f32_dpp v244, v232, v232 row_ror:4 row_mask:0xf bank_mask:0xf
    v_max_f32_dpp v245, v234, v234 row_ror:4 row_mask:0xf bank_mask:0xf
    v_max_f32_dpp v246, v236, v236 row_ror:4 row_mask:0xf bank_mask:0xf
    v_max_f32_dpp v247, v238, v238 row_ror:4 row_mask:0xf bank_mask:0xf
    v_max_f32_dpp v240, v240, v240 row_ror:8 row_mask:0xf bank_mask:0xf
    v_max_f32_dpp v241, v241, v241 row_ror:8 row_mask:0xf bank_mask:0xf
    v_max_f32_dpp v242, v242, v242 row_ror:8 row_mask:0xf bank_mask:0xf
    v_max_f32_dpp v243, v243, v243 row_ror:8 row_mask:0xf bank_mask:0xf
    v_max_f32_dpp v244, v244, v244 row_ror:8 row_mask:0xf bank_mask:0xf
    v_max_f32_dpp v245, v245, v245 row_ror:8 row_mask:0xf bank_mask:0xf
    v_max_f32_dpp v246, v246, v246 row_ror:8 row_mask:0xf bank_mask:0xf
    v_max_f32_dpp v247, v247, v247 row_ror:8 row_mask:0xf bank_mask:0xf
    v_sub_f32 v208, v224, v240
    v_sub_f32 v209, v226, v241
    v_sub_f32 v210, v228, v242
    v_sub_f32 v211, v230, v243
    v_sub_f32 v212, v232, v244
    v_sub_f32 v213, v234, v245
    v_sub_f32 v214, v236, v246
    v_sub_f32 v215, v238, v247
    v_mul_f32 v208, s94, v208
    v_mul_f32 v209, s94, v209
    v_mul_f32 v210, s94, v210
    v_mul_f32 v211, s94, v211
    v_mul_f32 v212, s94, v212
    v_mul_f32 v213, s94, v213
    v_mul_f32 v214, s94, v214
    v_mul_f32 v215, s94, v215
    v_exp_f32 v208, v208
    v_exp_f32 v209, v209
    v_exp_f32 v210, v210
    v_exp_f32 v211, v211
    v_exp_f32 v212, v212
    v_exp_f32 v213, v213
    v_exp_f32 v214, v214
    v_exp_f32 v215, v215
    v_mul_f32 v248, v208, v225
    v_mul_f32 v249, v209, v227
    v_mul_f32 v250, v210, v229
    v_mul_f32 v251, v211, v231
    v_mul_f32 v252, v212, v233
    v_mul_f32 v253, v213, v235
    v_mul_f32 v254, v214, v237
    v_mul_f32 v255, v215, v239
    v_add_f32_dpp v248, v248, v248 row_ror:4 row_mask:0xf bank_mask:0xf
    v_add_f32_dpp v249, v249, v249 row_ror:4 row_mask:0xf bank_mask:0xf
    v_add_f32_dpp v250, v250, v250 row_ror:4 row_mask:0xf bank_mask:0xf
    v_add_f32_dpp v251, v251, v251 row_ror:4 row_mask:0xf bank_mask:0xf
    v_add_f32_dpp v252, v252, v252 row_ror:4 row_mask:0xf bank_mask:0xf
    v_add_f32_dpp v253, v253, v253 row_ror:4 row_mask:0xf bank_mask:0xf
    v_add_f32_dpp v254, v254, v254 row_ror:4 row_mask:0xf bank_mask:0xf
    v_add_f32_dpp v255, v255, v255 row_ror:4 row_mask:0xf bank_mask:0xf
    v_add_f32_dpp v248, v248, v248 row_ror:8 row_mask:0xf bank_mask:0xf
    v_add_f32_dpp v249, v249, v249 row_ror:8 row_mask:0xf bank_mask:0xf
    v_add_f32_dpp v250, v250, v250 row_ror:8 row_mask:0xf bank_mask:0xf
    v_add_f32_dpp v251, v251, v251 row_ror:8 row_mask:0xf bank_mask:0xf
    v_add_f32_dpp v252, v252, v252 row_ror:8 row_mask:0xf bank_mask:0xf
    v_add_f32_dpp v253, v253, v253 row_ror:8 row_mask:0xf bank_mask:0xf
    v_add_f32_dpp v254, v254, v254 row_ror:8 row_mask:0xf bank_mask:0xf
    v_add_f32_dpp v255, v255, v255 row_ror:8 row_mask:0xf bank_mask:0xf
    v_rcp_f32 v248, v248
    v_rcp_f32 v249, v249
    v_rcp_f32 v250, v250
    v_rcp_f32 v251, v251
    v_rcp_f32 v252, v252
    v_rcp_f32 v253, v253
    v_rcp_f32 v254, v254
    v_rcp_f32 v255, v255
    v_mul_f32 v224, v208, v248
    v_mul_f32 v226, v209, v249
    v_mul_f32 v228, v210, v250
    v_mul_f32 v230, v211, v251
    v_mul_f32 v232, v212, v252
    v_mul_f32 v234, v213, v253
    v_mul_f32 v236, v214, v254
    v_mul_f32 v238, v215, v255
    v_lshlrev_b32 v28, 4, v0
    v_mov_b32 v7, 0x7ffffff0
    v_cmp_gt_u32 vcc, 44, v0
    s_nop 1
    v_cndmask_b32 v7, v7, v28, vcc
    v_lshlrev_b32 v20, 16, v22
    v_and_b32 v21, 0xffff0000, v22
    s_add_u32 s4, s3, 0
    s_add_u32 s5, s3, 4096
L_nopub:
    s_mov_b32 s93, 0
    s_cmp_lg_u32 s72, 1
    s_cbranch_scc1 L_tkw
    s_lshl_b32 s76, s86, 7
    s_add_u32 s76, s76, 152576
    s_cmp_lt_u32 s78, 64
    s_mov_b32 s82, 0x10001
    s_cselect_b32 s81, 0x10000, s82
    v_mov_b32 v22, s81
    v_mov_b32 v7, 0
    s_mov_b64 exec, 1
    buffer_atomic_add v22, v7, s[20:23], s76 offen sc0 sc1
    s_waitcnt vmcnt(0)
    v_add_u32 v22, 1, v22
    s_nop 0
    v_readfirstlane_b32 s81, v22
    v_and_b32 v22, 0xffff, v22
    v_min_u32 v22, 64, v22
    ds_write_b32 v7, v22 offset:7208
    s_lshr_b32 s81, s81, 16
    s_mov_b32 s82, 4
    s_cmp_ge_u32 s81, 96
    s_cselect_b32 s82, 3, s82
    s_cmp_ge_u32 s81, 116
    s_cselect_b32 s82, 2, s82
    v_mov_b32 v22, s82
    ds_min_u32 v7, v22 offset:7212
    s_mov_b64 exec, -1
L_tkw:
    s_cmp_lt_u32 s78, 64
    s_cbranch_scc1 L_nostage
    v_bfe_u32 v27, v0, 3, 2
    v_lshlrev_b32 v27, 3, v27
    v_lshrrev_b32 v19, 5, v0
    v_lshl_add_u32 v27, v19, 1, v27
    v_bfe_u32 v19, v0, 2, 1
    v_add_u32 v27, v27, v19
    v_mul_u32_u24 v27, 2752, v27
    v_and_b32 v19, 3, v0
    v_lshl_add_u32 v27, v19, 4, v27
    s_mul_i32 s83, s72, 352256
    v_add_u32 v27, s83, v27
    s_lshl_b32 s83, s72, 8
    v_add_u32 v6, s83, v6
    s_lshl_b32 s83, s72, 12
    s_add_u32 s83, s83, 8192
    v_lshrrev_b32 v26, 2, v0
    v_lshlrev_b32 v26, 5, v26
    v_lshl_add_u32 v26, v19, 14, v26
    v_add_u32 v26, s83, v26
    v_mov_b32 v7, 0
    s_mov_b32 s92, 0
L_tk_spin:
    ds_read_b32 v12, v7 offset:7208
    s_waitcnt lgkmcnt(0)
    v_cmp_eq_u32 vcc, -1, v12
    s_cbranch_vccz L_tk_ok
    s_sleep 4
    s_add_u32 s92, s92, 1
    s_cmp_lt_u32 s92, 65536
    s_cbranch_scc1 L_tk_spin
    s_mov_b64 exec, -1
L_tk_ok:
    s_nop 1
    v_readfirstlane_b32 s77, v12
    s_nop 1
    s_min_u32 s77, s77, 64
    s_add_u32 s77, s77, s96
    s_cmp_lt_u32 s77, s97
    s_cbranch_scc0 L_nostage
    s_mov_b32 s93, 1
    v_mov_b32 v12, 2
    ds_min_u32 v7, v12 offset:7212
    s_lshl_b32 s96, s77, 6
    v_add_u32 v25, s96, v25
    s_lshl_b32 s97, s77, 15
    buffer_load_dwordx4 v[160:163], v27, s[28:31], s96 offen
    buffer_load_dwordx4 v[164:167], v27, s[32:35], s96 offen
    s_add_u32 s96, s96, 11008
    buffer_load_dwordx4 v[168:171], v27, s[28:31], s96 offen
    buffer_load_dwordx4 v[172:175], v27, s[32:35], s96 offen
    s_add_u32 s96, s96, 77056
    s_waitcnt vmcnt(3)
    buffer_load_dwordx4 v[176:179], v27, s[28:31], s96 offen
    s_waitcnt vmcnt(3)
    buffer_load_dwordx4 v[180:183], v27, s[32:35], s96 offen
    s_add_u32 s96, s96, 11008
    s_waitcnt vmcnt(3)
    buffer_load_dwordx4 v[184:187], v27, s[28:31], s96 offen
    s_waitcnt vmcnt(3)
    buffer_load_dwordx4 v[188:191], v27, s[32:35], s96 offen
    s_add_u32 s96, s96, 77056
    s_waitcnt vmcnt(3)
    buffer_load_dwordx4 v[192:195], v27, s[28:31], s96 offen
    s_waitcnt vmcnt(3)
    buffer_load_dwordx4 v[196:199], v27, s[32:35], s96 offen
    s_add_u32 s96, s96, 11008
    s_waitcnt vmcnt(3)
    buffer_load_dwordx4 v[200:203], v27, s[28:31], s96 offen
    s_waitcnt vmcnt(3)
    buffer_load_dwordx4 v[204:207], v27, s[32:35], s96 offen
    s_add_u32 s96, s96, 77056
    s_waitcnt vmcnt(3)
    buffer_load_dwordx4 v[208:211], v27, s[28:31], s96 offen
    s_waitcnt vmcnt(3)
    buffer_load_dwordx4 v[212:215], v27, s[32:35], s96 offen
    s_add_u32 s96, s96, 11008
    s_waitcnt vmcnt(3)
    buffer_load_dwordx4 v[216:219], v27, s[28:31], s96 offen
    s_waitcnt vmcnt(3)
    buffer_load_dwordx4 v[220:223], v27, s[32:35], s96 offen
    s_add_u32 s96, s96, 77056
    s_waitcnt vmcnt(14)
    ds_write_b128 v26, v[160:163] offset:0
    ds_write_b128 v26, v[164:167] offset:16
    s_waitcnt vmcnt(12)
    ds_write_b128 v26, v[168:171] offset:512
    ds_write_b128 v26, v[172:175] offset:528
    s_waitcnt vmcnt(10)
    ds_write_b128 v26, v[176:179] offset:1024
    ds_write_b128 v26, v[180:183] offset:1040
    s_waitcnt vmcnt(8)
    ds_write_b128 v26, v[184:187] offset:1536
    ds_write_b128 v26, v[188:191] offset:1552
    s_waitcnt vmcnt(6)
    ds_write_b128 v26, v[192:195] offset:2048
    ds_write_b128 v26, v[196:199] offset:2064
    s_waitcnt vmcnt(4)
    ds_write_b128 v26, v[200:203] offset:2560
    ds_write_b128 v26, v[204:207] offset:2576
    s_waitcnt vmcnt(2)
    ds_write_b128 v26, v[208:211] offset:3072
    ds_write_b128 v26, v[212:215] offset:3088
    s_waitcnt vmcnt(0)
    ds_write_b128 v26, v[216:219] offset:3584
    ds_write_b128 v26, v[220:223] offset:3600
L_nostage:
    v_lshlrev_b32 v1, 4, v0
    s_waitcnt vmcnt(0) lgkmcnt(0)
    s_barrier
    ds_read_b128 v[192:195], v2 offset:2048
    ds_read_b128 v[196:199], v3 offset:2048
    ds_read_b128 v[200:203], v4 offset:2048
    ds_read_b128 v[204:207], v5 offset:2048
    s_waitcnt lgkmcnt(3)
    v_mfma_f32_16x16x32_bf16 v[160:163], v[192:195], v[32:35], 0
    s_waitcnt lgkmcnt(2)
    v_mfma_f32_16x16x32_bf16 v[160:163], v[196:199], v[36:39], v[160:163]
    s_waitcnt lgkmcnt(1)
    v_mfma_f32_16x16x32_bf16 v[160:163], v[200:203], v[40:43], v[160:163]
    s_waitcnt lgkmcnt(0)
    v_mfma_f32_16x16x32_bf16 v[160:163], v[204:207], v[44:47], v[160:163]
    v_mfma_f32_16x16x32_bf16 v[164:167], v[192:195], v[48:51], 0
    v_mfma_f32_16x16x32_bf16 v[164:167], v[196:199], v[52:55], v[164:167]
    v_mfma_f32_16x16x32_bf16 v[164:167], v[200:203], v[56:59], v[164:167]
    v_mfma_f32_16x16x32_bf16 v[164:167], v[204:207], v[60:63], v[164:167]
    v_mfma_f32_16x16x32_bf16 v[168:171], v[192:195], v[64:67], 0
    s_nop 2
    v_pk_mul_f32 v[216:217], v[160:161], s[8:9]
    v_mfma_f32_16x16x32_bf16 v[168:171], v[196:199], v[68:71], v[168:171]
    v_pk_fma_f32 v[216:217], v[162:163], s[10:11], v[216:217]
    v_mfma_f32_16x16x32_bf16 v[168:171], v[200:203], v[72:75], v[168:171]
    v_add_f32 v216, v216, v217
    v_mfma_f32_16x16x32_bf16 v[168:171], v[204:207], v[76:79], v[168:171]
    s_nop 0
    v_min_u32_dpp v12, v216, v23 quad_perm:[0,1,2,3] row_mask:0x1 bank_mask:0xf
    v_mfma_f32_16x16x32_bf16 v[172:175], v[192:195], v[80:83], 0
    v_pk_mul_f32 v[218:219], v[164:165], s[8:9]
    v_mfma_f32_16x16x32_bf16 v[172:175], v[196:199], v[84:87], v[172:175]
    v_pk_fma_f32 v[218:219], v[166:167], s[10:11], v[218:219]
    v_mfma_f32_16x16x32_bf16 v[172:175], v[200:203], v[88:91], v[172:175]
    v_add_f32 v218, v218, v219
    v_mfma_f32_16x16x32_bf16 v[172:175], v[204:207], v[92:95], v[172:175]
    s_nop 0
    v_min_u32_dpp v13, v218, v23 quad_perm:[0,1,2,3] row_mask:0x1 bank_mask:0xf
    v_mfma_f32_16x16x32_bf16 v[176:179], v[192:195], v[96:99], 0
    v_pk_mul_f32 v[216:217], v[168:169], s[8:9]
    v_mfma_f32_16x16x32_bf16 v[176:179], v[196:199], v[100:103], v[176:179]
    v_pk_fma_f32 v[216:217], v[170:171], s[10:11], v[216:217]
    v_mfma_f32_16x16x32_bf16 v[176:179], v[200:203], v[104:107], v[176:179]
    v_add_f32 v216, v216, v217
    v_mfma_f32_16x16x32_bf16 v[176:179], v[204:207], v[108:111], v[176:179]
    s_nop 0
    v_min_u32_dpp v14, v216, v23 quad_perm:[0,1,2,3] row_mask:0x1 bank_mask:0xf
    v_mfma_f32_16x16x32_bf16 v[180:183], v[192:195], v[112:115], 0
    v_pk_mul_f32 v[218:219], v[172:173], s[8:9]
    v_mfma_f32_16x16x32_bf16 v[180:183], v[196:199], v[116:119], v[180:183]
    v_pk_fma_f32 v[218:219], v[174:175], s[10:11], v[218:219]
    v_mfma_f32_16x16x32_bf16 v[180:183], v[200:203], v[120:123], v[180:183]
    v_add_f32 v218, v218, v219
    v_mfma_f32_16x16x32_bf16 v[180:183], v[204:207], v[124:127], v[180:183]
    s_nop 0
    v_min_u32_dpp v15, v218, v23 quad_perm:[0,1,2,3] row_mask:0x1 bank_mask:0xf
    v_mfma_f32_16x16x32_bf16 v[184:187], v[192:195], v[128:131], 0
    v_pk_mul_f32 v[216:217], v[176:177], s[8:9]
    v_mfma_f32_16x16x32_bf16 v[184:187], v[196:199], v[132:135], v[184:187]
    v_pk_fma_f32 v[216:217], v[178:179], s[10:11], v[216:217]
    v_mfma_f32_16x16x32_bf16 v[184:187], v[200:203], v[136:139], v[184:187]
    v_add_f32 v216, v216, v217
    v_mfma_f32_16x16x32_bf16 v[184:187], v[204:207], v[140:143], v[184:187]
    s_nop 0
    v_min_u32_dpp v12, v216, v23 quad_perm:[0,1,2,3] row_mask:0x2 bank_mask:0xf
    v_mfma_f32_16x16x32_bf16 v[188:191], v[192:195], v[144:147], 0
    v_pk_mul_f32 v[218:219], v[180:181], s[8:9]
    v_mfma_f32_16x16x32_bf16 v[188:191], v[196:199], v[148:151], v[188:191]
    v_pk_fma_f32 v[218:219], v[182:183], s[10:11], v[218:219]
    v_mfma_f32_16x16x32_bf16 v[188:191], v[200:203], v[152:155], v[188:191]
    v_add_f32 v218, v218, v219
    v_mfma_f32_16x16x32_bf16 v[188:191], v[204:207], v[156:159], v[188:191]
    s_nop 0
    v_min_u32_dpp v13, v218, v23 quad_perm:[0,1,2,3] row_mask:0x2 bank_mask:0xf
    v_pk_mul_f32 v[216:217], v[184:185], s[8:9]
    v_pk_fma_f32 v[216:217], v[186:187], s[10:11], v[216:217]
    v_add_f32 v216, v216, v217
    s_nop 1
    v_min_u32_dpp v14, v216, v23 quad_perm:[0,1,2,3] row_mask:0x2 bank_mask:0xf
    v_pk_mul_f32 v[218:219], v[188:189], s[8:9]
    v_pk_fma_f32 v[218:219], v[190:191], s[10:11], v[218:219]
    v_add_f32 v218, v218, v219
    s_nop 1
    v_min_u32_dpp v15, v218, v23 quad_perm:[0,1,2,3] row_mask:0x2 bank_mask:0xf
    s_mov_b32 exec_hi, 0
    buffer_store_dwordx4 v[12:15], v24, s[20:23], 0 offen sc1
    s_mov_b64 exec, -1
    s_cmp_eq_u32 s93, 1
    s_cbranch_scc1 L_ffn
    s_cmp_lt_u32 s79, 64
    s_cbranch_scc0 L_end2
    s_mov_b32 s92, 0
    buffer_load_dwordx4 v[32:35], v28, s[20:23], s4 offen offset:0 sc1
    buffer_load_dwordx4 v[36:39], v28, s[20:23], s4 offen offset:1024 sc1
    buffer_load_dwordx4 v[40:43], v28, s[20:23], s4 offen offset:2048 sc1
    buffer_load_dwordx4 v[44:47], v28, s[20:23], s4 offen offset:3072 sc1
    buffer_load_dwordx4 v[48:51], v28, s[20:23], s5 offen offset:0 sc1
    buffer_load_dwordx4 v[52:55], v28, s[20:23], s5 offen offset:1024 sc1
    buffer_load_dwordx4 v[56:59], v28, s[20:23], s5 offen offset:2048 sc1
    buffer_load_dwordx4 v[60:63], v28, s[20:23], s5 offen offset:3072 sc1
    s_sleep 2
L_y_poll:
    buffer_load_dwordx4 v[32:35], v28, s[20:23], s4 offen offset:0 sc1
    buffer_load_dwordx4 v[36:39], v28, s[20:23], s4 offen offset:1024 sc1
    buffer_load_dwordx4 v[40:43], v28, s[20:23], s4 offen offset:2048 sc1
    buffer_load_dwordx4 v[44:47], v28, s[20:23], s4 offen offset:3072 sc1
    buffer_load_dwordx4 v[48:51], v28, s[20:23], s5 offen offset:0 sc1
    buffer_load_dwordx4 v[52:55], v28, s[20:23], s5 offen offset:1024 sc1
    buffer_load_dwordx4 v[56:59], v28, s[20:23], s5 offen offset:2048 sc1
    buffer_load_dwordx4 v[60:63], v28, s[20:23], s5 offen offset:3072 sc1
    s_mov_b64 exec, -1
    s_waitcnt vmcnt(8)
    v_max3_u32 v102, v32, v33, v34
    v_max3_u32 v102, v102, v35, v36
    v_max3_u32 v102, v102, v37, v38
    v_max3_u32 v102, v102, v39, v40
    v_max3_u32 v102, v102, v41, v42
    v_max3_u32 v102, v102, v43, v44
    v_max3_u32 v102, v102, v45, v46
    v_max3_u32 v102, v102, v47, v48
    v_max3_u32 v102, v102, v49, v50
    v_max3_u32 v102, v102, v51, v52
    v_max3_u32 v102, v102, v53, v54
    v_max3_u32 v102, v102, v55, v56
    v_max3_u32 v102, v102, v57, v58
    v_max3_u32 v102, v102, v59, v60
    v_max3_u32 v102, v102, v61, v62
    v_max_u32 v102, v102, v63
    v_cmp_eq_u32 vcc, -1, v102
    s_cbranch_vccz L_y_done
    s_nop 0
    s_mov_b64 exec, vcc
    s_add_u32 s92, s92, 1
    s_cmp_lt_u32 s92, 65536
    s_cbranch_scc1 L_y_poll
    s_mov_b64 exec, -1
L_y_done:
    s_nop 1
    v_pk_mul_f32 v[96:97], v[32:33], v[224:225] op_sel_hi:[1,0]
    v_pk_mul_f32 v[98:99], v[34:35], v[224:225] op_sel_hi:[1,0]
    v_pk_fma_f32 v[96:97], v[36:37], v[226:227], v[96:97] op_sel_hi:[1,0,1]
    v_pk_fma_f32 v[98:99], v[38:39], v[226:227], v[98:99] op_sel_hi:[1,0,1]
    v_pk_fma_f32 v[96:97], v[40:41], v[228:229], v[96:97] op_sel_hi:[1,0,1]
    v_pk_fma_f32 v[98:99], v[42:43], v[228:229], v[98:99] op_sel_hi:[1,0,1]
    v_pk_fma_f32 v[96:97], v[44:45], v[230:231], v[96:97] op_sel_hi:[1,0,1]
    v_pk_fma_f32 v[98:99], v[46:47], v[230:231], v[98:99] op_sel_hi:[1,0,1]
    v_pk_fma_f32 v[96:97], v[48:49], v[232:233], v[96:97] op_sel_hi:[1,0,1]
    v_pk_fma_f32 v[98:99], v[50:51], v[232:233], v[98:99] op_sel_hi:[1,0,1]
    v_pk_fma_f32 v[96:97], v[52:53], v[234:235], v[96:97] op_sel_hi:[1,0,1]
    v_pk_fma_f32 v[98:99], v[54:55], v[234:235], v[98:99] op_sel_hi:[1,0,1]
    v_pk_fma_f32 v[96:97], v[56:57], v[236:237], v[96:97] op_sel_hi:[1,0,1]
    v_pk_fma_f32 v[98:99], v[58:59], v[236:237], v[98:99] op_sel_hi:[1,0,1]
    v_pk_fma_f32 v[96:97], v[60:61], v[238:239], v[96:97] op_sel_hi:[1,0,1]
    v_pk_fma_f32 v[98:99], v[62:63], v[238:239], v[98:99] op_sel_hi:[1,0,1]
    s_nop 1
    v_permlane32_swap_b32 v96, v98
    v_permlane32_swap_b32 v97, v99
    v_pk_add_f32 v[96:97], v[96:97], v[98:99]
    v_mov_b32 v98, v96
    v_mov_b32 v99, v97
    s_nop 0
    v_permlane16_swap_b32 v96, v98
    v_permlane16_swap_b32 v97, v99
    v_pk_add_f32 v[96:97], v[96:97], v[98:99]
    s_nop 1
    v_add_f32_dpp v96, v96, v96 row_ror:4 row_mask:0xf bank_mask:0xf
    v_add_f32_dpp v97, v97, v97 row_ror:4 row_mask:0xf bank_mask:0xf
    s_nop 0
    v_add_f32_dpp v96, v96, v96 row_ror:8 row_mask:0xf bank_mask:0xf
    v_add_f32_dpp v97, v97, v97 row_ror:8 row_mask:0xf bank_mask:0xf
    v_cvt_pk_bf16_f32 v98, v96, v97
    v_lshlrev_b32 v96, 16, v98
    v_and_b32 v97, 0xffff0000, v98
    v_pk_add_f32 v[96:97], v[96:97], v[20:21]
    v_cvt_pk_bf16_f32 v100, v96, v97
    v_min_u32 v98, -2, v100
    buffer_store_dword v98, v26, s[20:23], 0 offen sc1
    v_lshlrev_b32 v20, 16, v100
    v_and_b32 v21, 0xffff0000, v100
    s_add_u32 s4, s3, 0x4000
    s_mov_b32 s92, 0
    buffer_load_dwordx4 v[64:67], v28, s[20:23], s4 offen offset:0 sc1
    buffer_load_dwordx4 v[68:71], v28, s[20:23], s4 offen offset:1024 sc1
    buffer_load_dwordx4 v[72:75], v7, s[20:23], s4 offen offset:2048 sc1
    s_sleep 2
L_o_poll:
    buffer_load_dwordx4 v[64:67], v28, s[20:23], s4 offen offset:0 sc1
    buffer_load_dwordx4 v[68:71], v28, s[20:23], s4 offen offset:1024 sc1
    buffer_load_dwordx4 v[72:75], v7, s[20:23], s4 offen offset:2048 sc1
    s_mov_b64 exec, -1
    s_waitcnt vmcnt(3)
    v_max3_u32 v102, v64, v65, v66
    v_max3_u32 v102, v102, v67, v68
    v_max3_u32 v102, v102, v69, v70
    v_max3_u32 v102, v102, v71, v72
    v_max3_u32 v102, v102, v73, v74
    v_max_u32 v102, v102, v75
    v_cmp_eq_u32 vcc, -1, v102
    s_cbranch_vccz L_o_done
    s_nop 0
    s_mov_b64 exec, vcc
    s_add_u32 s92, s92, 1
    s_cmp_lt_u32 s92, 65536
    s_cbranch_scc1 L_o_poll
    s_mov_b64 exec, -1
L_o_done:
    s_nop 1
    v_pk_add_f32 v[96:97], v[64:65], v[68:69]
    v_pk_add_f32 v[98:99], v[66:67], v[70:71]
    v_pk_add_f32 v[96:97], v[96:97], v[72:73]
    v_pk_add_f32 v[98:99], v[98:99], v[74:75]
    s_nop 1
    v_permlane32_swap_b32 v96, v98
    v_permlane32_swap_b32 v97, v99
    v_pk_add_f32 v[96:97], v[96:97], v[98:99]
    v_mov_b32 v98, v96
    v_mov_b32 v99, v97
    s_nop 0
    v_permlane16_swap_b32 v96, v98
    v_permlane16_swap_b32 v97, v99
    v_pk_add_f32 v[96:97], v[96:97], v[98:99]
    s_nop 1
    v_add_f32_dpp v96, v96, v96 row_ror:4 row_mask:0xf bank_mask:0xf
    v_add_f32_dpp v97, v97, v97 row_ror:4 row_mask:0xf bank_mask:0xf
    s_nop 0
    v_add_f32_dpp v96, v96, v96 row_ror:8 row_mask:0xf bank_mask:0xf
    v_add_f32_dpp v97, v97, v97 row_ror:8 row_mask:0xf bank_mask:0xf
    v_cvt_pk_bf16_f32 v98, v96, v97
    v_lshlrev_b32 v96, 16, v98
    v_and_b32 v97, 0xffff0000, v98
    v_pk_add_f32 v[96:97], v[96:97], v[20:21]
    v_cvt_pk_bf16_f32 v100, v96, v97
    s_mov_b32 exec_lo, 15
    s_mov_b32 exec_hi, 15
    buffer_store_dword v100, v27, s[40:43], 0 offen sc1
    s_mov_b64 exec, -1
    s_endpgm
L_ffn:
    buffer_load_dwordx4 v[32:35], v6, s[36:39], s97 offen offset:0
    buffer_load_dwordx4 v[36:39], v6, s[36:39], s97 offen offset:1024
    buffer_load_dwordx4 v[40:43], v6, s[36:39], s97 offen offset:2048
    buffer_load_dwordx4 v[44:47], v6, s[36:39], s97 offen offset:3072
    s_add_u32 s97, s97, 4096
    buffer_load_dwordx4 v[48:51], v6, s[36:39], s97 offen offset:0
    buffer_load_dwordx4 v[52:55], v6, s[36:39], s97 offen offset:1024
    buffer_load_dwordx4 v[56:59], v6, s[36:39], s97 offen offset:2048
    buffer_load_dwordx4 v[60:63], v6, s[36:39], s97 offen offset:3072
    s_lshl_b32 s83, s72, 14
    s_add_u32 s83, s83, 8192
    v_lshrrev_b32 v99, 4, v0
    v_lshlrev_b32 v96, 8, v99
    v_bfe_u32 v97, v0, 2, 2
    v_lshl_add_u32 v96, v97, 5, v96
    v_and_b32 v97, 3, v0
    v_lshl_add_u32 v96, v97, 3, v96
    v_add_u32 v96, s83, v96
    ds_read_b64_tr_b16 v[160:161], v96 offset:0
    ds_read_b64_tr_b16 v[162:163], v96 offset:128
    ds_read_b64_tr_b16 v[164:165], v96 offset:1024
    ds_read_b64_tr_b16 v[166:167], v96 offset:1152
    ds_read_b64_tr_b16 v[168:169], v96 offset:2048
    ds_read_b64_tr_b16 v[170:171], v96 offset:2176
    ds_read_b64_tr_b16 v[172:173], v96 offset:3072
    ds_read_b64_tr_b16 v[174:175], v96 offset:3200
    ds_read_b64_tr_b16 v[176:177], v96 offset:4096
    ds_read_b64_tr_b16 v[178:179], v96 offset:4224
    ds_read_b64_tr_b16 v[180:181], v96 offset:5120
    ds_read_b64_tr_b16 v[182:183], v96 offset:5248
    ds_read_b64_tr_b16 v[184:185], v96 offset:6144
    ds_read_b64_tr_b16 v[186:187], v96 offset:6272
    ds_read_b64_tr_b16 v[188:189], v96 offset:7168
    ds_read_b64_tr_b16 v[190:191], v96 offset:7296
    ds_read_b64_tr_b16 v[192:193], v96 offset:8192
    ds_read_b64_tr_b16 v[194:195], v96 offset:8320
    ds_read_b64_tr_b16 v[196:197], v96 offset:9216
    ds_read_b64_tr_b16 v[198:199], v96 offset:9344
    ds_read_b64_tr_b16 v[200:201], v96 offset:10240
    ds_read_b64_tr_b16 v[202:203], v96 offset:10368
    ds_read_b64_tr_b16 v[204:205], v96 offset:11264
    ds_read_b64_tr_b16 v[206:207], v96 offset:11392
    ds_read_b64_tr_b16 v[208:209], v96 offset:12288
    ds_read_b64_tr_b16 v[210:211], v96 offset:12416
    ds_read_b64_tr_b16 v[212:213], v96 offset:13312
    ds_read_b64_tr_b16 v[214:215], v96 offset:13440
    ds_read_b64_tr_b16 v[216:217], v96 offset:14336
    ds_read_b64_tr_b16 v[218:219], v96 offset:14464
    ds_read_b64_tr_b16 v[220:221], v96 offset:15360
    ds_read_b64_tr_b16 v[222:223], v96 offset:15488
    s_mov_b32 s81, s95
    v_add_u32 v7, s83, v1
    v_and_b32 v98, 1, v0
    v_mul_u32_u24 v96, 1088, v98
    v_lshl_add_u32 v96, v99, 4, v96
    v_add_u32 v96, s83, v96
    v_mul_u32_u24 v98, 80, v98
    v_lshl_add_u32 v98, v99, 4, v98
    v_lshrrev_b32 v97, 1, v99
    v_mul_u32_u24 v97, 80, v97
    v_and_b32 v100, 7, v0
    v_lshl_add_u32 v97, v100, 1, v97
    s_lshl_b32 s83, s72, 4
    v_add_u32 v97, s83, v97
    v_mov_b32 v99, 0x3d372713
    s_mov_b32 s88, 0
    s_mov_b32 s89, -1
    v_mov_b32 v140, 0x3f803f80
    v_mov_b32 v141, 0x3f803f80
    v_mov_b32 v142, 0x3f803f80
    v_mov_b32 v143, 0x3f803f80
    s_waitcnt lgkmcnt(0)
    s_nop 0
    v_mfma_f32_16x16x32_bf16 v[136:139], v[140:143], v[160:163], 0
    v_mfma_f32_16x16x32_bf16 v[136:139], v[140:143], v[164:167], v[136:139]
    v_mfma_f32_16x16x32_bf16 v[136:139], v[140:143], v[168:171], v[136:139]
    v_mfma_f32_16x16x32_bf16 v[136:139], v[140:143], v[172:175], v[136:139]
    v_mfma_f32_16x16x32_bf16 v[136:139], v[140:143], v[176:179], v[136:139]
    v_mfma_f32_16x16x32_bf16 v[136:139], v[140:143], v[180:183], v[136:139]
    v_mfma_f32_16x16x32_bf16 v[136:139], v[140:143], v[184:187], v[136:139]
    v_mfma_f32_16x16x32_bf16 v[136:139], v[140:143], v[188:191], v[136:139]
    v_mfma_f32_16x16x32_bf16 v[136:139], v[140:143], v[192:195], v[136:139]
    v_mfma_f32_16x16x32_bf16 v[136:139], v[140:143], v[196:199], v[136:139]
    v_mfma_f32_16x16x32_bf16 v[136:139], v[140:143], v[200:203], v[136:139]
    v_mfma_f32_16x16x32_bf16 v[136:139], v[140:143], v[204:207], v[136:139]
    v_mfma_f32_16x16x32_bf16 v[136:139], v[140:143], v[208:211], v[136:139]
    v_mfma_f32_16x16x32_bf16 v[136:139], v[140:143], v[212:215], v[136:139]
    v_mfma_f32_16x16x32_bf16 v[136:139], v[140:143], v[216:219], v[136:139]
    v_mfma_f32_16x16x32_bf16 v[136:139], v[140:143], v[220:223], v[136:139]
    s_waitcnt vmcnt(0)
    v_perm_b32 v224, v36, v32, s84
    v_perm_b32 v225, v44, v40, s84
    v_perm_b32 v226, v52, v48, s84
    v_perm_b32 v227, v60, v56, s84
    v_perm_b32 v228, v36, v32, s85
    v_perm_b32 v229, v44, v40, s85
    v_perm_b32 v230, v52, v48, s85
    v_perm_b32 v231, v60, v56, s85
    v_perm_b32 v232, v37, v33, s84
    v_perm_b32 v233, v45, v41, s84
    v_perm_b32 v234, v53, v49, s84
    v_perm_b32 v235, v61, v57, s84
    v_perm_b32 v236, v37, v33, s85
    v_perm_b32 v237, v45, v41, s85
    v_perm_b32 v238, v53, v49, s85
    v_perm_b32 v239, v61, v57, s85
    v_perm_b32 v240, v38, v34, s84
    v_perm_b32 v241, v46, v42, s84
    v_perm_b32 v242, v54, v50, s84
    v_perm_b32 v243, v62, v58, s84
    v_perm_b32 v244, v38, v34, s85
    v_perm_b32 v245, v46, v42, s85
    v_perm_b32 v246, v54, v50, s85
    v_perm_b32 v247, v62, v58, s85
    v_perm_b32 v248, v39, v35, s84
    v_perm_b32 v249, v47, v43, s84
    v_perm_b32 v250, v55, v51, s84
    v_perm_b32 v251, v63, v59, s84
    v_perm_b32 v252, v39, v35, s85
    v_perm_b32 v253, v47, v43, s85
    v_perm_b32 v254, v55, v51, s85
    v_perm_b32 v255, v63, v59, s85
    s_mov_b32 s92, 0
    buffer_load_dwordx4 v[144:147], v1, s[20:23], s81 offen sc1
    buffer_load_dwordx4 v[148:151], v1, s[20:23], s81 offen offset:1024 sc1
    s_sleep 2
L_h_poll:
    buffer_load_dwordx4 v[144:147], v1, s[20:23], s81 offen sc1
    buffer_load_dwordx4 v[148:151], v1, s[20:23], s81 offen offset:1024 sc1
    s_mov_b64 exec, -1
    s_waitcnt vmcnt(2)
    v_max3_u32 v112, v144, v145, v146
    v_max3_u32 v112, v112, v147, v148
    v_max3_u32 v112, v112, v149, v150
    v_max_u32 v112, v112, v151
    v_cmp_eq_u32 vcc, -1, v112
    s_cbranch_vccz L_h_done
    s_nop 0
    s_mov_b64 exec, vcc
    s_add_u32 s92, s92, 1
    s_cmp_lt_u32 s92, 65536
    s_cbranch_scc1 L_h_poll
    s_mov_b64 exec, -1
L_h_done:
    s_nop 1
    ds_write_b128 v7, v[144:147]
    ds_write_b128 v7, v[148:151] offset:1088
    ds_read_b128 v[32:35], v96 offset:0
    ds_read_b128 v[36:39], v96 offset:64
    ds_read_b128 v[40:43], v96 offset:128
    ds_read_b128 v[44:47], v96 offset:192
    ds_read_b128 v[48:51], v96 offset:256
    ds_read_b128 v[52:55], v96 offset:320
    ds_read_b128 v[56:59], v96 offset:384
    ds_read_b128 v[60:63], v96 offset:448
    ds_read_b128 v[64:67], v96 offset:512
    ds_read_b128 v[68:71], v96 offset:576
    ds_read_b128 v[72:75], v96 offset:640
    ds_read_b128 v[76:79], v96 offset:704
    v_dot2_f32_bf16 v112, v144, v140, 0
    v_dot2_f32_bf16 v113, v148, v140, 0
    v_dot2_f32_bf16 v114, v144, v144, 0
    v_dot2_f32_bf16 v115, v148, v148, 0
    v_dot2_f32_bf16 v112, v145, v140, v112
    v_dot2_f32_bf16 v113, v149, v140, v113
    v_dot2_f32_bf16 v114, v145, v145, v114
    v_dot2_f32_bf16 v115, v149, v149, v115
    ds_read_b128 v[80:83], v96 offset:768
    ds_read_b128 v[84:87], v96 offset:832
    ds_read_b128 v[88:91], v96 offset:896
    ds_read_b128 v[92:95], v96 offset:960
    v_dot2_f32_bf16 v112, v146, v140, v112
    v_dot2_f32_bf16 v113, v150, v140, v113
    v_dot2_f32_bf16 v114, v146, v146, v114
    v_dot2_f32_bf16 v115, v150, v150, v115
    v_dot2_f32_bf16 v112, v147, v140, v112
    v_dot2_f32_bf16 v113, v151, v140, v113
    v_dot2_f32_bf16 v114, v147, v147, v114
    v_dot2_f32_bf16 v115, v151, v151, v115
    s_waitcnt lgkmcnt(15)
    v_mfma_f32_16x16x32_bf16 v[8:11], v[32:35], v[160:163], 0
    v_permlane32_swap_b32 v112, v113
    v_permlane32_swap_b32 v114, v115
    s_waitcnt lgkmcnt(14)
    v_mfma_f32_16x16x32_bf16 v[8:11], v[36:39], v[164:167], v[8:11]
    v_add_f32 v112, v112, v113
    v_add_f32 v114, v114, v115
    s_waitcnt lgkmcnt(13)
    v_mfma_f32_16x16x32_bf16 v[8:11], v[40:43], v[168:171], v[8:11]
    v_permlane16_swap_b32 v112, v114
    v_add_f32 v112, v112, v114
    s_waitcnt lgkmcnt(12)
    v_mfma_f32_16x16x32_bf16 v[8:11], v[44:47], v[172:175], v[8:11]
    v_add_f32_dpp v112, v112, v112 row_ror:8 row_mask:0xf bank_mask:0xf
    s_waitcnt lgkmcnt(11)
    v_mfma_f32_16x16x32_bf16 v[8:11], v[48:51], v[176:179], v[8:11]
    v_add_f32_dpp v112, v112, v112 row_ror:4 row_mask:0xf bank_mask:0xf
    s_waitcnt lgkmcnt(10)
    v_mfma_f32_16x16x32_bf16 v[8:11], v[52:55], v[180:183], v[8:11]
    v_add_f32_dpp v112, v112, v112 row_ror:2 row_mask:0xf bank_mask:0xf
    s_waitcnt lgkmcnt(9)
    v_mfma_f32_16x16x32_bf16 v[8:11], v[56:59], v[184:187], v[8:11]
    v_add_f32_dpp v112, v112, v112 row_ror:1 row_mask:0xf bank_mask:0xf
    v_mul_f32 v112, 0x3b000000, v112
    v_mov_b32 v114, v112
    s_waitcnt lgkmcnt(8)
    v_mfma_f32_16x16x32_bf16 v[8:11], v[60:63], v[188:191], v[8:11]
    v_permlane16_swap_b32 v112, v114
    v_fma_f32 v114, -v112, v112, v114
    s_waitcnt lgkmcnt(7)
    v_mfma_f32_16x16x32_bf16 v[8:11], v[64:67], v[192:195], v[8:11]
    v_max_f32 v114, 0, v114
    v_cvt_pk_bf16_f32 v114, v114, v114
    v_and_b32 v114, 0xffff0000, v114
    s_waitcnt lgkmcnt(6)
    v_mfma_f32_16x16x32_bf16 v[8:11], v[68:71], v[196:199], v[8:11]
    v_add_f32 v114, 0x3727c5ac, v114
    v_cvt_pk_bf16_f32 v114, v114, v114
    v_and_b32 v114, 0xffff0000, v114
    s_waitcnt lgkmcnt(5)
    v_mfma_f32_16x16x32_bf16 v[8:11], v[72:75], v[200:203], v[8:11]
    v_sqrt_f32 v114, v114
    v_cvt_pk_bf16_f32 v112, v112, v112
    s_waitcnt lgkmcnt(4)
    v_mfma_f32_16x16x32_bf16 v[8:11], v[76:79], v[204:207], v[8:11]
    v_and_b32 v112, 0xffff0000, v112
    v_cvt_pk_bf16_f32 v114, v114, v114
    v_and_b32 v114, 0xffff0000, v114
    s_waitcnt lgkmcnt(3)
    v_mfma_f32_16x16x32_bf16 v[8:11], v[80:83], v[208:211], v[8:11]
    v_rcp_f32 v114, v114
    v_mul_f32 v112, v112, v136
    s_waitcnt lgkmcnt(2)
    v_mfma_f32_16x16x32_bf16 v[8:11], v[84:87], v[212:215], v[8:11]
    v_mul_f32 v112, v112, v114
    s_waitcnt lgkmcnt(1)
    v_mfma_f32_16x16x32_bf16 v[8:11], v[88:91], v[216:219], v[8:11]
    s_waitcnt lgkmcnt(0)
    v_mfma_f32_16x16x32_bf16 v[8:11], v[92:95], v[220:223], v[8:11]
    s_nop 7
    v_cndmask_b32 v152, v8, v9, s[88:89]
    v_fma_f32 v152, v152, v114, -v112
    v_cvt_pk_bf16_f32 v152, v152, v152
    v_and_b32 v152, 0xffff0000, v152
    v_mul_f32 v154, v152, v152
    v_mul_f32 v155, 0xc0135761, v152
    v_fma_f32 v154, v154, v99, 1.0
    v_mul_f32 v154, v154, v155
    v_exp_f32 v154, v154
    v_mul_f32_dpp v153, v152, v152 row_ror:8 row_mask:0xf bank_mask:0xf
    v_add_f32 v154, 1.0, v154
    v_rcp_f32 v154, v154
    s_mov_b64 exec, s[90:91]
    v_mul_f32 v154, v154, v153
    v_cvt_pk_bf16_f32 v154, v154, v154
    ds_write_b16 v97, v154 offset:6912
    s_mov_b64 exec, -1
    s_waitcnt lgkmcnt(0)
    s_barrier
    ds_read_b128 v[132:135], v98 offset:6912
    s_waitcnt lgkmcnt(0)
    v_mfma_f32_16x16x32_bf16 v[32:35], v[132:135], v[224:227], 0
    v_mfma_f32_16x16x32_bf16 v[36:39], v[132:135], v[228:231], 0
    v_mfma_f32_16x16x32_bf16 v[40:43], v[132:135], v[232:235], 0
    v_mfma_f32_16x16x32_bf16 v[44:47], v[132:135], v[236:239], 0
    s_nop 4
    v_min_u32_dpp v12, v32, v23 quad_perm:[0,1,2,3] row_mask:0x1 bank_mask:0xf
    s_nop 1
    v_min_u32_dpp v12, v33, v23 quad_perm:[0,1,2,3] row_mask:0x2 bank_mask:0xf
    v_mfma_f32_16x16x32_bf16 v[48:51], v[132:135], v[240:243], 0
    v_min_u32_dpp v13, v36, v23 quad_perm:[0,1,2,3] row_mask:0x1 bank_mask:0xf
    s_nop 1
    v_min_u32_dpp v13, v37, v23 quad_perm:[0,1,2,3] row_mask:0x2 bank_mask:0xf
    v_mfma_f32_16x16x32_bf16 v[52:55], v[132:135], v[244:247], 0
    v_min_u32_dpp v14, v40, v23 quad_perm:[0,1,2,3] row_mask:0x1 bank_mask:0xf
    s_nop 1
    v_min_u32_dpp v14, v41, v23 quad_perm:[0,1,2,3] row_mask:0x2 bank_mask:0xf
    v_mfma_f32_16x16x32_bf16 v[56:59], v[132:135], v[248:251], 0
    v_min_u32_dpp v15, v44, v23 quad_perm:[0,1,2,3] row_mask:0x1 bank_mask:0xf
    s_nop 1
    v_min_u32_dpp v15, v45, v23 quad_perm:[0,1,2,3] row_mask:0x2 bank_mask:0xf
    v_mfma_f32_16x16x32_bf16 v[60:63], v[132:135], v[252:255], 0
    v_min_u32_dpp v12, v48, v23 quad_perm:[0,1,2,3] row_mask:0x4 bank_mask:0xf
    s_nop 1
    v_min_u32_dpp v12, v49, v23 quad_perm:[0,1,2,3] row_mask:0x8 bank_mask:0xf
    v_min_u32_dpp v13, v52, v23 quad_perm:[0,1,2,3] row_mask:0x4 bank_mask:0xf
    s_nop 1
    v_min_u32_dpp v13, v53, v23 quad_perm:[0,1,2,3] row_mask:0x8 bank_mask:0xf
    v_min_u32_dpp v14, v56, v23 quad_perm:[0,1,2,3] row_mask:0x4 bank_mask:0xf
    s_nop 1
    v_min_u32_dpp v14, v57, v23 quad_perm:[0,1,2,3] row_mask:0x8 bank_mask:0xf
    v_min_u32_dpp v15, v60, v23 quad_perm:[0,1,2,3] row_mask:0x4 bank_mask:0xf
    s_nop 1
    v_min_u32_dpp v15, v61, v23 quad_perm:[0,1,2,3] row_mask:0x8 bank_mask:0xf
    buffer_store_dwordx4 v[12:15], v25, s[20:23], 0 offen sc1
L_end2:
    s_endpgm
L_end:
    s_endpgm
.section .rodata,"a"
.p2align 6
.amdhsa_kernel sequential_preLN__mha_block_cached__geglu_ffn__decode_kernel
  .amdhsa_next_free_vgpr 256
  .amdhsa_next_free_sgpr 102
  .amdhsa_accum_offset 256
  .amdhsa_group_segment_fixed_size 0
  .amdhsa_kernarg_size 96
  .amdhsa_user_sgpr_count 2
  .amdhsa_user_sgpr_kernarg_segment_ptr 1
  .amdhsa_system_sgpr_workgroup_id_x 1
  .amdhsa_float_denorm_mode_32 3
.end_amdhsa_kernel
```
